```python
import torch

def _softmax(x, axis=-1):
    return torch.softmax(x, dim=axis)
def _gelu(x):
    return torch.nn.functional.gelu(x, approximate="tanh")
def _silu(x):
    return torch.nn.functional.silu(x)
def _sigmoid(x):
    return torch.sigmoid(x)
def _layernorm(x, axis=-1, eps=1e-5):
    m = x.mean(dim=axis, keepdim=True)
    v = x.var(dim=axis, keepdim=True, unbiased=False)
    return (x - m) / torch.sqrt(v + eps)
def _scatter_add(tgt, idx, src, axis=0):
    return tgt.clone().index_add_(axis, idx, src)
def _segment_sum(src, seg, n):
    out = torch.zeros((n,) + src.shape[1:], dtype=src.dtype)
    return out.index_add_(0, seg, src)
def _pad(x, pw):
    flat = tuple(v for pair in reversed(pw) for v in pair)
    return torch.nn.functional.pad(x, flat)

kernel_name = 'concat_heads__linear_kernel_hedgehog__ssm_conv_s4d__prompt'

def setup_inputs():

    _w = (lambda a: (lambda t: t.to(torch.bfloat16) if t.is_floating_point() else t)(torch.as_tensor(a)))
    def _A_setup():
        B, S, D, H = 1, 2048, 512, 32
        Dh = D // H
        return {
            "x": _w((lambda *s: torch.randn(*s, dtype=torch.bfloat16) * 0.4)(B, S, D)),
            "wqkv": _w((lambda *s: torch.randn(*s, dtype=torch.bfloat16) * 0.4)(D, 3 * D)),
            "w_phi": _w((lambda *s: torch.randn(*s, dtype=torch.bfloat16) * 0.4)(H, Dh, Dh) * (Dh ** -0.5)),
            "wo": _w((lambda *s: torch.randn(*s, dtype=torch.bfloat16) * 0.05)(D, D)),
        }
    _A_in = _A_setup()

    def _B_setup():
        Bsz, L, D, N = 1, 2048, 512, 128
        return {
            "u": _w((lambda *s: torch.randn(*s, dtype=torch.bfloat16) * 0.05)(Bsz, L, D)),
            "log_A_real": _w((lambda *s: torch.randn(*s, dtype=torch.bfloat16) * 3.2)(D, N) * 0.5),
            "A_imag": _w((lambda *s: torch.randn(*s, dtype=torch.bfloat16) * 0.2)(D, N) * 3.14),
            "C_real": _w((lambda *s: torch.randn(*s, dtype=torch.bfloat16) * 3.2)(D, N) / N ** 0.5),
            "C_imag": _w((lambda *s: torch.randn(*s, dtype=torch.bfloat16) * 3.2)(D, N) / N ** 0.5),
            "log_dt": _w((lambda *s: torch.randn(*s, dtype=torch.bfloat16) * 0.2)(D) * 0.5 - 4.0),
            "D_skip": _w((lambda *s: torch.randn(*s, dtype=torch.bfloat16) * 0.4)(D)),
        }
    _B_in = _B_setup()

    return {
        "A_x": _A_in["x"],
        "A_wqkv": _A_in["wqkv"],
        "A_w_phi": _A_in["w_phi"],
        "A_wo": _A_in["wo"],
        "B_u": _B_in["u"],
        "B_log_A_real": _B_in["log_A_real"],
        "B_A_imag": _B_in["A_imag"],
        "B_C_real": _B_in["C_real"],
        "B_C_imag": _B_in["C_imag"],
        "B_log_dt": _B_in["log_dt"],
        "B_D_skip": _B_in["D_skip"],
    }

def reference(A_x, A_wqkv, A_w_phi, A_wo, B_u, B_log_A_real, B_A_imag, B_C_real, B_C_imag, B_log_dt, B_D_skip):
    def _A_ref(x, wqkv, w_phi, wo):
        B, S, D = x.shape
        H = 32; Dh = D // H
        qkv = (lambda x, *d: x.permute(*d))((x @ wqkv).reshape(B, S, 3, H, Dh), 2, 0, 3, 1, 4)
        q, k, v = qkv[0], qkv[1], qkv[2]
        pq = torch.einsum("bhsd,hdf->bhsf", q, w_phi)
        pk = torch.einsum("bhsd,hdf->bhsf", k, w_phi)
        phi_q = torch.concatenate([_softmax(pq, axis=-1), _softmax(-pq, axis=-1)], axis=-1)
        phi_k = torch.concatenate([_softmax(pk, axis=-1), _softmax(-pk, axis=-1)], axis=-1)
        kv = torch.einsum("bhsf,bhsd->bhfd", phi_k, v)
        z  = torch.einsum("bhsf->bhf", phi_k)
        num = torch.einsum("bhqf,bhfd->bhqd", phi_q, kv)
        den = torch.einsum("bhqf,bhf->bhq", phi_q, z)[..., None] + 1e-6
        o = num / den
        return (lambda x, *d: x.permute(*d))(o, 0, 2, 1, 3).reshape(B, S, D) @ wo

    def _B_ref(u, log_A_real, A_imag, C_real, C_imag, log_dt, D_skip):
        L = u.shape[1]
        dt = torch.exp(log_dt)
        A = -torch.exp(log_A_real) + 1j * A_imag
        C = (C_real + 1j * C_imag) * dt[:, None]
        pos = (lambda x, dt: x.to(dt))(torch.arange(L), log_dt.dtype)
        P = torch.exp((A * dt[:, None])[:, :, None] * pos[None, None, :])
        K = 2.0 * torch.einsum("dn,dnl->dl", C, P).real
        L2 = 2 * L
        u_t = (lambda x, *d: x.permute(*d))(u, 0, 2, 1)
        Kf = (lambda x, *a, **k: torch.fft.rfft(x.float(), *a, **k))(K, L2)
        Uf = (lambda x, *a, **k: torch.fft.rfft(x.float(), *a, **k))(u_t, L2)
        y = (lambda x, *a, **k: torch.fft.irfft(x, *a, **k).to(torch.bfloat16))(Uf * Kf[None, :, :], L2)[:, :, :L]
        y = (lambda x, *d: x.permute(*d))(y, 0, 2, 1)
        return y + u * D_skip[None, None, :]

    a = _A_ref(A_x, A_wqkv, A_w_phi, A_wo)
    b = _B_ref(B_u, B_log_A_real, B_A_imag, B_C_real, B_C_imag, B_log_dt, B_D_skip)
    return torch.concatenate([a, b], axis=-1)
```

```asm
; @launch grid=(256,1,1) block=(512,1,1) lds=163840
.amdgcn_target "amdgcn-amd-amdhsa--gfx950"
.text
.globl concat_heads__linear_kernel_hedgehog__ssm_conv_s4d__prompt_kernel
.p2align 8
.type concat_heads__linear_kernel_hedgehog__ssm_conv_s4d__prompt_kernel,@function
concat_heads__linear_kernel_hedgehog__ssm_conv_s4d__prompt_kernel:
    s_cmp_ge_u32 s2, 256
    s_cbranch_scc1 END
    v_lshrrev_b32 v2, 6, v0
    v_and_b32 v1, 63, v0
    s_and_b32 s60, s2, 7
    s_lshr_b32 s61, s2, 3
    v_readfirstlane_b32 s3, v2
    v_and_b32 v3, 7, v0
    v_bfe_u32 v2, v0, 4, 1
    v_lshlrev_b32 v2, 6, v2
    v_lshlrev_b32 v15, 4, v3
    v_xor_b32 v15, v15, v2
    s_lshl_b32 s64, s3, 12
    s_cmp_ge_u32 s2, 128
    s_cbranch_scc1 BPATH
    s_load_dwordx2 s[32:33], s[0:1], 0
    s_mov_b32 s34, 2097152
    s_mov_b32 s35, 0x20000
    s_load_dwordx2 s[36:37], s[0:1], 8
    s_mov_b32 s38, 1572864
    s_mov_b32 s39, 0x20000
    s_load_dwordx2 s[52:53], s[0:1], 104
    s_mov_b32 s54, 16777216
    s_mov_b32 s55, 0x20000
    s_load_dwordx2 s[44:45], s[0:1], 24
    s_mov_b32 s46, 524288
    s_mov_b32 s47, 0x20000
    s_load_dwordx2 s[48:49], s[0:1], 88
    s_mov_b32 s50, 4194304
    s_mov_b32 s51, 0x20000
    s_load_dwordx2 s[56:57], s[0:1], 96
    s_mov_b32 s58, 256
    s_mov_b32 s59, 0x20000
    s_load_dwordx2 s[40:41], s[0:1], 16
    s_mov_b32 s42, 16384
    s_mov_b32 s43, 0x20000
    s_lshr_b32 s4, s60, 1
    s_and_b32 s5, s61, 3
    s_lshl2_add_u32 s62, s4, s5
    s_and_b32 s4, s60, 1
    s_lshr_b32 s5, s61, 2
    s_lshl2_add_u32 s63, s4, s5
    v_lshrrev_b32 v5, 3, v1
    v_lshrrev_b32 v4, 4, v1
    v_xor_b32 v4, v4, v3
    v_lshlrev_b32 v4, 4, v4
    s_lshl3_add_u32 s4, s62, s3
    s_lshl_b32 s4, s4, 14
    v_lshl_add_u32 v2, v5, 10, v4
    v_add_u32 v2, s4, v2
    v_xor_b32 v3, 64, v2
    v_add_u32 v3, 0x1400, v3
    s_mul_i32 s4, s3, 0x6000
    s_lshl_b32 s5, s63, 7
    s_add_u32 s4, s4, s5
    v_mul_u32_u24 v4, 0xc00, v5
    v_add3_u32 v4, v4, s4, v15
    s_lshr_b32 s5, s61, 2
    s_add_u32 s68, s61, s5
    s_lshl_b32 s68, s68, 8
    s_and_b32 s68, s68, 0x3ff
    s_mul_i32 s69, s68, 0x600
    s_mov_b32 m0, s64
    s_waitcnt lgkmcnt(0)
    buffer_load_dwordx4 v2, s[32:35], s68 offen lds
    buffer_load_dwordx4 v4, s[36:39], s69 offen offset:1024 lds
    buffer_load_dwordx4 v4, s[36:39], s69 offen offset:2048 lds
    buffer_load_dwordx4 v3, s[32:35], s68 offen offset:3072 lds
    s_add_u32 s68, s68, 128
    s_and_b32 s68, s68, 0x3ff
    s_mul_i32 s69, s68, 0x600
    s_barrier
    s_add_u32 m0, s64, 32768
    s_nop 0
    buffer_load_dwordx4 v2, s[32:35], s68 offen lds
    buffer_load_dwordx4 v4, s[36:39], s69 offen offset:1024 lds
    buffer_load_dwordx4 v4, s[36:39], s69 offen offset:2048 lds
    buffer_load_dwordx4 v3, s[32:35], s68 offen offset:3072 lds
    s_add_u32 s68, s68, 128
    s_and_b32 s68, s68, 0x3ff
    s_mul_i32 s69, s68, 0x600
    s_lshr_b32 s66, s61, 3
    s_lshl2_add_u32 s66, s60, s66
    s_and_b32 s67, s61, 7
    s_lshl_b32 s4, s3, 13
    s_lshl_b32 s5, s67, 7
    s_add_u32 s4, s4, s5
    v_lshrrev_b32 v14, 3, v1
    v_lshlrev_b32 v14, 10, v14
    v_add3_u32 v14, v14, s4, v15
    v_lshrrev_b32 v12, 5, v1
    v_bfe_u32 v9, v1, 2, 2
    v_lshlrev_b32 v9, 7, v9
    v_bfe_u32 v10, v1, 3, 1
    v_lshl_add_u32 v9, v10, 6, v9
    v_bfe_u32 v10, v1, 4, 1
    v_lshl_add_u32 v10, v10, 5, v9
    v_and_b32 v6, 1, v1
    v_lshlrev_b32 v6, 4, v6
    v_mov_b32 v7, 0x3f80
    v_lshlrev_b32 v11, v6, v7
    s_lshr_b32 s70, s3, 2
    s_and_b32 s71, s3, 3
    s_lshl4_add_u32 s76, s63, s62
    s_mul_i32 s76, s76, 4352
    s_lshl2_add_u32 s4, s62, s71
    s_lshl_b32 s4, s4, 15
    s_lshl1_add_u32 s5, s63, s70
    s_lshl_b32 s5, s5, 11
    s_add_u32 s4, s4, s5
    s_add_u32 s77, s4, 1048576
    v_lshlrev_b32 v15, 4, v1
    s_lshl1_add_u32 s4, s63, s70
    s_lshl_b32 s16, s4, 10
    buffer_load_dwordx4 v[96:99], v15, s[40:43], s16 offen
    s_lshl_b32 s4, s3, 10
    s_add_u32 s4, s4, 24576
    s_mov_b32 s17, s4
    v_add_u32 v112, s4, v15
    v_and_b32 v5, 1, v1
    v_lshlrev_b32 v5, 9, v5
    v_lshl_add_u32 v5, v12, 7, v5
    v_bfe_u32 v6, v1, 2, 2
    v_lshl_add_u32 v5, v6, 5, v5
    v_and_b32 v6, 16, v1
    v_and_b32 v7, 2, v1
    v_lshl_add_u32 v6, v7, 2, v6
    v_add3_u32 v113, v5, v6, s4
    v_bfe_u32 v5, v1, 2, 1
    v_cmp_eq_u32 s[72:73], 0, v5
    v_bfe_u32 v5, v1, 1, 2
    v_bfe_u32 v6, v1, 1, 1
    v_lshlrev_b32 v5, 1, v5
    v_sub_u32 v5, v5, v6
    v_bfe_u32 v6, v1, 4, 1
    v_lshl_add_u32 v5, v6, 1, v5
    v_bfe_u32 v6, v1, 3, 1
    v_xor_b32 v6, v6, v12
    v_lshl_add_u32 v5, v6, 3, v5
    v_bfe_u32 v6, v1, 1, 3
    v_cmp_eq_u32 s[24:25], 0, v5
    v_cmp_eq_u32 s[26:27], 1, v5
    v_cmp_eq_u32 s[28:29], 2, v5
    v_cmp_eq_u32 s[30:31], 3, v5
    v_cndmask_b32 v88, 0, v11, s[24:25]
    v_cndmask_b32 v89, 0, v11, s[26:27]
    v_cndmask_b32 v90, 0, v11, s[28:29]
    v_cndmask_b32 v91, 0, v11, s[30:31]
    v_cmp_eq_u32 s[24:25], 4, v5
    v_cmp_eq_u32 s[26:27], 5, v5
    v_cmp_eq_u32 s[28:29], 6, v5
    v_cmp_eq_u32 s[30:31], 7, v5
    v_cndmask_b32 v92, 0, v11, s[24:25]
    v_cndmask_b32 v93, 0, v11, s[26:27]
    v_cndmask_b32 v94, 0, v11, s[28:29]
    v_cndmask_b32 v95, 0, v11, s[30:31]
    v_cmp_eq_u32 s[24:25], 0, v6
    v_cmp_eq_u32 s[26:27], 1, v6
    v_cmp_eq_u32 s[28:29], 2, v6
    v_cmp_eq_u32 s[30:31], 3, v6
    v_cndmask_b32 v104, 0, v11, s[24:25]
    v_cndmask_b32 v105, 0, v11, s[26:27]
    v_cndmask_b32 v106, 0, v11, s[28:29]
    v_cndmask_b32 v107, 0, v11, s[30:31]
    v_cmp_eq_u32 s[24:25], 4, v6
    v_cmp_eq_u32 s[26:27], 5, v6
    v_cmp_eq_u32 s[28:29], 6, v6
    v_cmp_eq_u32 s[30:31], 7, v6
    v_cndmask_b32 v108, 0, v11, s[24:25]
    v_cndmask_b32 v109, 0, v11, s[26:27]
    v_cndmask_b32 v110, 0, v11, s[28:29]
    v_cndmask_b32 v111, 0, v11, s[30:31]
    v_bfe_u32 v5, v1, 4, 1
    v_lshlrev_b32 v5, 12, v5
    v_bfe_u32 v6, v1, 3, 1
    v_mul_u32_u24 v6, 0xc00, v6
    v_and_b32 v7, 7, v1
    v_lshlrev_b32 v7, 7, v7
    v_add3_u32 v5, v5, v6, v7
    v_bfe_u32 v6, v1, 1, 3
    v_xor_b32 v6, v6, v12
    s_lshl_b32 s4, s71, 13
    v_lshlrev_b32 v6, 4, v6
    v_add3_u32 v5, v5, v6, s4
    v_xor_b32 v6, 32, v5
    v_xor_b32 v7, 64, v5
    v_xor_b32 v8, 0x60, v5
    v_and_b32 v9, 3, v1
    v_lshl_add_u32 v9, v9, 3, v10
    s_lshl_b32 s4, s70, 6
    v_xor_b32 v9, s4, v9
    v_lshl_add_u32 v9, v12, 12, v9
    s_waitcnt vmcnt(5) lgkmcnt(0)
    s_barrier
    ds_read_b128 v[128:131], v5 offset:0
    ds_read_b64_tr_b16 v[16:17], v9 offset:1024
    ds_read_b64_tr_b16 v[18:19], v9 offset:1536
    ds_read_b64_tr_b16 v[20:21], v9 offset:2048
    ds_read_b64_tr_b16 v[22:23], v9 offset:2560
    ds_read_b128 v[132:135], v6 offset:0
    ds_read_b64_tr_b16 v[24:25], v9 offset:9216
    ds_read_b64_tr_b16 v[26:27], v9 offset:9728
    ds_read_b64_tr_b16 v[28:29], v9 offset:10240
    ds_read_b64_tr_b16 v[30:31], v9 offset:10752
    s_add_u32 m0, s64, 65536
    s_nop 0
    buffer_load_dwordx4 v2, s[32:35], s68 offen lds
    buffer_load_dwordx4 v4, s[36:39], s69 offen offset:1024 lds
    buffer_load_dwordx4 v4, s[36:39], s69 offen offset:2048 lds
    buffer_load_dwordx4 v3, s[32:35], s68 offen offset:3072 lds
    s_add_u32 s68, s68, 128
    s_and_b32 s68, s68, 0x3ff
    s_mul_i32 s69, s68, 0x600
    s_waitcnt lgkmcnt(5)
    v_mfma_f32_32x32x16_bf16 v[48:63], v[16:19], v[128:131], 0
    ds_read_b128 v[136:139], v7 offset:0
    ds_read_b64_tr_b16 v[32:33], v9 offset:17408
    ds_read_b64_tr_b16 v[34:35], v9 offset:17920
    v_mfma_f32_32x32x16_bf16 v[64:79], v[128:131], v[20:23], 0
    ds_read_b64_tr_b16 v[36:37], v9 offset:18432
    ds_read_b64_tr_b16 v[38:39], v9 offset:18944
    s_waitcnt lgkmcnt(5)
    v_mfma_f32_32x32x16_bf16 v[48:63], v[24:27], v[132:135], v[48:63]
    ds_read_b128 v[140:143], v8 offset:0
    ds_read_b64_tr_b16 v[40:41], v9 offset:25600
    ds_read_b64_tr_b16 v[42:43], v9 offset:26112
    v_mfma_f32_32x32x16_bf16 v[64:79], v[132:135], v[28:31], v[64:79]
    ds_read_b64_tr_b16 v[44:45], v9 offset:26624
    ds_read_b64_tr_b16 v[46:47], v9 offset:27136
    s_add_u32 m0, s64, 98304
    s_nop 0
    buffer_load_dwordx4 v2, s[32:35], s68 offen lds
    buffer_load_dwordx4 v4, s[36:39], s69 offen offset:1024 lds
    buffer_load_dwordx4 v4, s[36:39], s69 offen offset:2048 lds
    buffer_load_dwordx4 v3, s[32:35], s68 offen offset:3072 lds
    s_add_u32 s68, s68, 128
    s_and_b32 s68, s68, 0x3ff
    s_mul_i32 s69, s68, 0x600
    s_waitcnt vmcnt(9) lgkmcnt(0)
    s_barrier
    v_mfma_f32_32x32x16_bf16 v[48:63], v[32:35], v[136:139], v[48:63]
    ds_read_b128 v[144:147], v5 offset:32768
    ds_read_b64_tr_b16 v[16:17], v9 offset:33792
    ds_read_b64_tr_b16 v[18:19], v9 offset:34304
    v_mfma_f32_32x32x16_bf16 v[64:79], v[136:139], v[36:39], v[64:79]
    ds_read_b64_tr_b16 v[20:21], v9 offset:34816
    ds_read_b64_tr_b16 v[22:23], v9 offset:35328
    s_add_u32 m0, s64, 131072
    s_nop 0
    buffer_load_dwordx4 v2, s[32:35], s68 offen lds
    v_mfma_f32_32x32x16_bf16 v[48:63], v[40:43], v[140:143], v[48:63]
    ds_read_b128 v[148:151], v6 offset:32768
    ds_read_b64_tr_b16 v[24:25], v9 offset:41984
    ds_read_b64_tr_b16 v[26:27], v9 offset:42496
    v_mfma_f32_32x32x16_bf16 v[64:79], v[140:143], v[44:47], v[64:79]
    ds_read_b64_tr_b16 v[28:29], v9 offset:43008
    ds_read_b64_tr_b16 v[30:31], v9 offset:43520
    buffer_load_dwordx4 v4, s[36:39], s69 offen offset:1024 lds
    s_waitcnt lgkmcnt(5)
    v_mfma_f32_32x32x16_bf16 v[48:63], v[16:19], v[144:147], v[48:63]
    ds_read_b128 v[152:155], v7 offset:32768
    ds_read_b64_tr_b16 v[32:33], v9 offset:50176
    ds_read_b64_tr_b16 v[34:35], v9 offset:50688
    v_mfma_f32_32x32x16_bf16 v[64:79], v[144:147], v[20:23], v[64:79]
    ds_read_b64_tr_b16 v[36:37], v9 offset:51200
    ds_read_b64_tr_b16 v[38:39], v9 offset:51712
    buffer_load_dwordx4 v4, s[36:39], s69 offen offset:2048 lds
    s_waitcnt lgkmcnt(5)
    v_mfma_f32_32x32x16_bf16 v[48:63], v[24:27], v[148:151], v[48:63]
    ds_read_b128 v[156:159], v8 offset:32768
    ds_read_b64_tr_b16 v[40:41], v9 offset:58368
    ds_read_b64_tr_b16 v[42:43], v9 offset:58880
    v_mfma_f32_32x32x16_bf16 v[64:79], v[148:151], v[28:31], v[64:79]
    ds_read_b64_tr_b16 v[44:45], v9 offset:59392
    ds_read_b64_tr_b16 v[46:47], v9 offset:59904
    buffer_load_dwordx4 v3, s[32:35], s68 offen offset:3072 lds
    s_add_u32 s68, s68, 128
    s_and_b32 s68, s68, 0x3ff
    s_mul_i32 s69, s68, 0x600
    v_add_u32 v5, 65536, v5
    v_add_u32 v6, 65536, v6
    v_add_u32 v7, 65536, v7
    v_add_u32 v8, 65536, v8
    v_add_u32 v9, 65536, v9
    s_waitcnt vmcnt(8) lgkmcnt(0)
    s_barrier
    v_mfma_f32_32x32x16_bf16 v[48:63], v[32:35], v[152:155], v[48:63]
    ds_read_b128 v[160:163], v5 offset:0
    ds_read_b64_tr_b16 v[16:17], v9 offset:1024
    ds_read_b64_tr_b16 v[18:19], v9 offset:1536
    v_mfma_f32_32x32x16_bf16 v[64:79], v[152:155], v[36:39], v[64:79]
    ds_read_b64_tr_b16 v[20:21], v9 offset:2048
    ds_read_b64_tr_b16 v[22:23], v9 offset:2560
    s_add_u32 m0, s64, 0
    s_nop 0
    buffer_load_dwordx4 v2, s[32:35], s68 offen lds
    v_mfma_f32_32x32x16_bf16 v[48:63], v[40:43], v[156:159], v[48:63]
    ds_read_b128 v[164:167], v6 offset:0
    ds_read_b64_tr_b16 v[24:25], v9 offset:9216
    ds_read_b64_tr_b16 v[26:27], v9 offset:9728
    v_mfma_f32_32x32x16_bf16 v[64:79], v[156:159], v[44:47], v[64:79]
    ds_read_b64_tr_b16 v[28:29], v9 offset:10240
    ds_read_b64_tr_b16 v[30:31], v9 offset:10752
    buffer_load_dwordx4 v4, s[36:39], s69 offen offset:1024 lds
    s_waitcnt lgkmcnt(5)
    v_mfma_f32_32x32x16_bf16 v[48:63], v[16:19], v[160:163], v[48:63]
    ds_read_b128 v[168:171], v7 offset:0
    ds_read_b64_tr_b16 v[32:33], v9 offset:17408
    ds_read_b64_tr_b16 v[34:35], v9 offset:17920
    v_mfma_f32_32x32x16_bf16 v[64:79], v[160:163], v[20:23], v[64:79]
    ds_read_b64_tr_b16 v[36:37], v9 offset:18432
    ds_read_b64_tr_b16 v[38:39], v9 offset:18944
    buffer_load_dwordx4 v4, s[36:39], s69 offen offset:2048 lds
    s_waitcnt lgkmcnt(5)
    v_mfma_f32_32x32x16_bf16 v[48:63], v[24:27], v[164:167], v[48:63]
    ds_read_b128 v[172:175], v8 offset:0
    ds_read_b64_tr_b16 v[40:41], v9 offset:25600
    ds_read_b64_tr_b16 v[42:43], v9 offset:26112
    v_mfma_f32_32x32x16_bf16 v[64:79], v[164:167], v[28:31], v[64:79]
    ds_read_b64_tr_b16 v[44:45], v9 offset:26624
    ds_read_b64_tr_b16 v[46:47], v9 offset:27136
    buffer_load_dwordx4 v3, s[32:35], s68 offen offset:3072 lds
    s_add_u32 s68, s68, 128
    s_and_b32 s68, s68, 0x3ff
    s_mul_i32 s69, s68, 0x600
    s_waitcnt vmcnt(8) lgkmcnt(0)
    s_barrier
    v_mfma_f32_32x32x16_bf16 v[48:63], v[32:35], v[168:171], v[48:63]
    ds_read_b128 v[176:179], v5 offset:32768
    ds_read_b64_tr_b16 v[16:17], v9 offset:33792
    ds_read_b64_tr_b16 v[18:19], v9 offset:34304
    v_mfma_f32_32x32x16_bf16 v[64:79], v[168:171], v[36:39], v[64:79]
    ds_read_b64_tr_b16 v[20:21], v9 offset:34816
    ds_read_b64_tr_b16 v[22:23], v9 offset:35328
    s_add_u32 m0, s64, 32768
    s_nop 0
    buffer_load_dwordx4 v2, s[32:35], s68 offen lds
    v_mfma_f32_32x32x16_bf16 v[48:63], v[40:43], v[172:175], v[48:63]
    ds_read_b128 v[180:183], v6 offset:32768
    ds_read_b64_tr_b16 v[24:25], v9 offset:41984
    ds_read_b64_tr_b16 v[26:27], v9 offset:42496
    v_mfma_f32_32x32x16_bf16 v[64:79], v[172:175], v[44:47], v[64:79]
    ds_read_b64_tr_b16 v[28:29], v9 offset:43008
    ds_read_b64_tr_b16 v[30:31], v9 offset:43520
    buffer_load_dwordx4 v4, s[36:39], s69 offen offset:1024 lds
    s_waitcnt lgkmcnt(5)
    v_mfma_f32_32x32x16_bf16 v[48:63], v[16:19], v[176:179], v[48:63]
    ds_read_b128 v[184:187], v7 offset:32768
    ds_read_b64_tr_b16 v[32:33], v9 offset:50176
    ds_read_b64_tr_b16 v[34:35], v9 offset:50688
    v_mfma_f32_32x32x16_bf16 v[64:79], v[176:179], v[20:23], v[64:79]
    ds_read_b64_tr_b16 v[36:37], v9 offset:51200
    ds_read_b64_tr_b16 v[38:39], v9 offset:51712
    buffer_load_dwordx4 v4, s[36:39], s69 offen offset:2048 lds
    s_waitcnt lgkmcnt(5)
    v_mfma_f32_32x32x16_bf16 v[48:63], v[24:27], v[180:183], v[48:63]
    ds_read_b128 v[188:191], v8 offset:32768
    ds_read_b64_tr_b16 v[40:41], v9 offset:58368
    ds_read_b64_tr_b16 v[42:43], v9 offset:58880
    v_mfma_f32_32x32x16_bf16 v[64:79], v[180:183], v[28:31], v[64:79]
    ds_read_b64_tr_b16 v[44:45], v9 offset:59392
    ds_read_b64_tr_b16 v[46:47], v9 offset:59904
    buffer_load_dwordx4 v3, s[32:35], s68 offen offset:3072 lds
    s_add_u32 s68, s68, 128
    s_and_b32 s68, s68, 0x3ff
    s_mul_i32 s69, s68, 0x600
    v_add_u32 v5, 65536, v5
    v_add_u32 v6, 65536, v6
    v_add_u32 v7, 65536, v7
    v_add_u32 v8, 65536, v8
    v_add_u32 v9, 65536, v9
    s_waitcnt vmcnt(8) lgkmcnt(0)
    s_barrier
    v_mfma_f32_32x32x16_bf16 v[48:63], v[32:35], v[184:187], v[48:63]
    ds_read_b128 v[192:195], v5 offset:0
    ds_read_b64_tr_b16 v[16:17], v9 offset:1024
    ds_read_b64_tr_b16 v[18:19], v9 offset:1536
    v_mfma_f32_32x32x16_bf16 v[64:79], v[184:187], v[36:39], v[64:79]
    ds_read_b64_tr_b16 v[20:21], v9 offset:2048
    ds_read_b64_tr_b16 v[22:23], v9 offset:2560
    s_add_u32 m0, s64, 65536
    s_nop 0
    buffer_load_dwordx4 v2, s[32:35], s68 offen lds
    v_mfma_f32_32x32x16_bf16 v[48:63], v[40:43], v[188:191], v[48:63]
    ds_read_b128 v[196:199], v6 offset:0
    ds_read_b64_tr_b16 v[24:25], v9 offset:9216
    ds_read_b64_tr_b16 v[26:27], v9 offset:9728
    v_mfma_f32_32x32x16_bf16 v[64:79], v[188:191], v[44:47], v[64:79]
    ds_read_b64_tr_b16 v[28:29], v9 offset:10240
    ds_read_b64_tr_b16 v[30:31], v9 offset:10752
    buffer_load_dwordx4 v4, s[36:39], s69 offen offset:1024 lds
    s_waitcnt lgkmcnt(5)
    v_mfma_f32_32x32x16_bf16 v[48:63], v[16:19], v[192:195], v[48:63]
    ds_read_b128 v[200:203], v7 offset:0
    ds_read_b64_tr_b16 v[32:33], v9 offset:17408
    ds_read_b64_tr_b16 v[34:35], v9 offset:17920
    v_mfma_f32_32x32x16_bf16 v[64:79], v[192:195], v[20:23], v[64:79]
    ds_read_b64_tr_b16 v[36:37], v9 offset:18432
    ds_read_b64_tr_b16 v[38:39], v9 offset:18944
    buffer_load_dwordx4 v4, s[36:39], s69 offen offset:2048 lds
    s_waitcnt lgkmcnt(5)
    v_mfma_f32_32x32x16_bf16 v[48:63], v[24:27], v[196:199], v[48:63]
    ds_read_b128 v[204:207], v8 offset:0
    ds_read_b64_tr_b16 v[40:41], v9 offset:25600
    ds_read_b64_tr_b16 v[42:43], v9 offset:26112
    v_mfma_f32_32x32x16_bf16 v[64:79], v[196:199], v[28:31], v[64:79]
    ds_read_b64_tr_b16 v[44:45], v9 offset:26624
    ds_read_b64_tr_b16 v[46:47], v9 offset:27136
    buffer_load_dwordx4 v3, s[32:35], s68 offen offset:3072 lds
    s_add_u32 s68, s68, 128
    s_and_b32 s68, s68, 0x3ff
    s_mul_i32 s69, s68, 0x600
    v_add_u32 v5, 4294836224, v5
    v_add_u32 v6, 4294836224, v6
    v_add_u32 v7, 4294836224, v7
    v_add_u32 v8, 4294836224, v8
    v_add_u32 v9, 4294836224, v9
    s_waitcnt vmcnt(8) lgkmcnt(0)
    s_barrier
    v_mfma_f32_32x32x16_bf16 v[48:63], v[32:35], v[200:203], v[48:63]
    ds_read_b128 v[208:211], v5 offset:0
    ds_read_b64_tr_b16 v[16:17], v9 offset:1024
    ds_read_b64_tr_b16 v[18:19], v9 offset:1536
    v_mfma_f32_32x32x16_bf16 v[64:79], v[200:203], v[36:39], v[64:79]
    ds_read_b64_tr_b16 v[20:21], v9 offset:2048
    ds_read_b64_tr_b16 v[22:23], v9 offset:2560
    s_add_u32 m0, s64, 98304
    s_nop 0
    buffer_load_dwordx4 v4, s[36:39], s69 offen lds
    s_add_u32 s68, s68, 128
    s_and_b32 s68, s68, 0x3ff
    s_mul_i32 s69, s68, 0x600
    v_mfma_f32_32x32x16_bf16 v[48:63], v[40:43], v[204:207], v[48:63]
    ds_read_b128 v[212:215], v6 offset:0
    ds_read_b64_tr_b16 v[24:25], v9 offset:9216
    ds_read_b64_tr_b16 v[26:27], v9 offset:9728
    v_mfma_f32_32x32x16_bf16 v[64:79], v[204:207], v[44:47], v[64:79]
    ds_read_b64_tr_b16 v[28:29], v9 offset:10240
    ds_read_b64_tr_b16 v[30:31], v9 offset:10752
    s_add_u32 m0, s64, 99328
    s_nop 0
    buffer_load_dwordx4 v4, s[36:39], s69 offen lds
    s_add_u32 s68, s68, 128
    s_and_b32 s68, s68, 0x3ff
    s_mul_i32 s69, s68, 0x600
    s_waitcnt lgkmcnt(5)
    v_mfma_f32_32x32x16_bf16 v[48:63], v[16:19], v[208:211], v[48:63]
    ds_read_b128 v[216:219], v7 offset:0
    ds_read_b64_tr_b16 v[32:33], v9 offset:17408
    ds_read_b64_tr_b16 v[34:35], v9 offset:17920
    v_mfma_f32_32x32x16_bf16 v[64:79], v[208:211], v[20:23], v[64:79]
    ds_read_b64_tr_b16 v[36:37], v9 offset:18432
    ds_read_b64_tr_b16 v[38:39], v9 offset:18944
    s_add_u32 m0, s64, 100352
    s_nop 0
    buffer_load_dwordx4 v4, s[36:39], s69 offen lds
    s_add_u32 s68, s68, 128
    s_and_b32 s68, s68, 0x3ff
    s_mul_i32 s69, s68, 0x600
    s_waitcnt lgkmcnt(5)
    v_mfma_f32_32x32x16_bf16 v[48:63], v[24:27], v[212:215], v[48:63]
    ds_read_b128 v[220:223], v8 offset:0
    ds_read_b64_tr_b16 v[40:41], v9 offset:25600
    ds_read_b64_tr_b16 v[42:43], v9 offset:26112
    v_mfma_f32_32x32x16_bf16 v[64:79], v[212:215], v[28:31], v[64:79]
    ds_read_b64_tr_b16 v[44:45], v9 offset:26624
    ds_read_b64_tr_b16 v[46:47], v9 offset:27136
    s_add_u32 m0, s64, 101376
    s_nop 0
    buffer_load_dwordx4 v4, s[36:39], s69 offen lds
    s_add_u32 s68, s68, 128
    s_and_b32 s68, s68, 0x3ff
    s_mul_i32 s69, s68, 0x600
    s_waitcnt vmcnt(8) lgkmcnt(0)
    s_barrier
    v_mfma_f32_32x32x16_bf16 v[48:63], v[32:35], v[216:219], v[48:63]
    s_mov_b32 m0, s17
    s_nop 0
    buffer_load_dwordx4 v15, s[40:43], s16 offen lds
    ds_read_b128 v[224:227], v5 offset:32768
    ds_read_b64_tr_b16 v[16:17], v9 offset:33792
    ds_read_b64_tr_b16 v[18:19], v9 offset:34304
    v_mfma_f32_32x32x16_bf16 v[64:79], v[216:219], v[36:39], v[64:79]
    ds_read_b64_tr_b16 v[20:21], v9 offset:34816
    ds_read_b64_tr_b16 v[22:23], v9 offset:35328
    s_add_u32 m0, s64, 131072
    s_nop 0
    buffer_load_dwordx4 v4, s[36:39], s69 offen lds
    s_add_u32 s68, s68, 128
    s_and_b32 s68, s68, 0x3ff
    s_mul_i32 s69, s68, 0x600
    v_mfma_f32_32x32x16_bf16 v[48:63], v[40:43], v[220:223], v[48:63]
    ds_read_b128 v[228:231], v6 offset:32768
    ds_read_b64_tr_b16 v[24:25], v9 offset:41984
    ds_read_b64_tr_b16 v[26:27], v9 offset:42496
    v_mfma_f32_32x32x16_bf16 v[64:79], v[220:223], v[44:47], v[64:79]
    ds_read_b64_tr_b16 v[28:29], v9 offset:43008
    ds_read_b64_tr_b16 v[30:31], v9 offset:43520
    s_add_u32 m0, s64, 132096
    s_nop 0
    buffer_load_dwordx4 v4, s[36:39], s69 offen lds
    s_add_u32 s68, s68, 128
    s_and_b32 s68, s68, 0x3ff
    s_mul_i32 s69, s68, 0x600
    s_waitcnt lgkmcnt(5)
    v_mfma_f32_32x32x16_bf16 v[48:63], v[16:19], v[224:227], v[48:63]
    ds_read_b128 v[232:235], v7 offset:32768
    ds_read_b64_tr_b16 v[32:33], v9 offset:50176
    ds_read_b64_tr_b16 v[34:35], v9 offset:50688
    v_mfma_f32_32x32x16_bf16 v[64:79], v[224:227], v[20:23], v[64:79]
    ds_read_b64_tr_b16 v[36:37], v9 offset:51200
    ds_read_b64_tr_b16 v[38:39], v9 offset:51712
    s_add_u32 m0, s64, 133120
    s_nop 0
    buffer_load_dwordx4 v4, s[36:39], s69 offen lds
    s_add_u32 s68, s68, 128
    s_and_b32 s68, s68, 0x3ff
    s_mul_i32 s69, s68, 0x600
    s_waitcnt lgkmcnt(5)
    v_mfma_f32_32x32x16_bf16 v[48:63], v[24:27], v[228:231], v[48:63]
    ds_read_b128 v[236:239], v8 offset:32768
    ds_read_b64_tr_b16 v[40:41], v9 offset:58368
    ds_read_b64_tr_b16 v[42:43], v9 offset:58880
    v_mfma_f32_32x32x16_bf16 v[64:79], v[228:231], v[28:31], v[64:79]
    ds_read_b64_tr_b16 v[44:45], v9 offset:59392
    ds_read_b64_tr_b16 v[46:47], v9 offset:59904
    s_add_u32 m0, s64, 134144
    s_nop 0
    buffer_load_dwordx4 v4, s[36:39], s69 offen lds
    s_add_u32 s68, s68, 128
    s_and_b32 s68, s68, 0x3ff
    s_mul_i32 s69, s68, 0x600
    v_add_u32 v5, 65536, v5
    v_add_u32 v6, 65536, v6
    v_add_u32 v7, 65536, v7
    v_add_u32 v8, 65536, v8
    v_add_u32 v9, 65536, v9
    s_waitcnt vmcnt(4) lgkmcnt(0)
    s_barrier
    v_mfma_f32_32x32x16_bf16 v[48:63], v[32:35], v[232:235], v[48:63]
    ds_read_b64_tr_b16 v[100:101], v113
    ds_read_b64_tr_b16 v[102:103], v113 offset:256
    ds_read_b128 v[240:243], v5 offset:0
    ds_read_b64_tr_b16 v[16:17], v9 offset:1024
    ds_read_b64_tr_b16 v[18:19], v9 offset:1536
    v_mfma_f32_32x32x16_bf16 v[64:79], v[232:235], v[36:39], v[64:79]
    ds_read_b64_tr_b16 v[20:21], v9 offset:2048
    ds_read_b64_tr_b16 v[22:23], v9 offset:2560
    v_mfma_f32_32x32x16_bf16 v[48:63], v[40:43], v[236:239], v[48:63]
    ds_read_b128 v[244:247], v6 offset:0
    ds_read_b64_tr_b16 v[24:25], v9 offset:9216
    ds_read_b64_tr_b16 v[26:27], v9 offset:9728
    v_mfma_f32_32x32x16_bf16 v[64:79], v[236:239], v[44:47], v[64:79]
    ds_read_b64_tr_b16 v[28:29], v9 offset:10240
    ds_read_b64_tr_b16 v[30:31], v9 offset:10752
    s_waitcnt lgkmcnt(5)
    v_mfma_f32_32x32x16_bf16 v[48:63], v[16:19], v[240:243], v[48:63]
    ds_read_b128 v[248:251], v7 offset:0
    ds_read_b64_tr_b16 v[32:33], v9 offset:17408
    ds_read_b64_tr_b16 v[34:35], v9 offset:17920
    v_mfma_f32_32x32x16_bf16 v[64:79], v[240:243], v[20:23], v[64:79]
    ds_read_b64_tr_b16 v[36:37], v9 offset:18432
    ds_read_b64_tr_b16 v[38:39], v9 offset:18944
    s_waitcnt lgkmcnt(5)
    v_mfma_f32_32x32x16_bf16 v[48:63], v[24:27], v[244:247], v[48:63]
    ds_read_b128 v[252:255], v8 offset:0
    ds_read_b64_tr_b16 v[40:41], v9 offset:25600
    ds_read_b64_tr_b16 v[42:43], v9 offset:26112
    v_mfma_f32_32x32x16_bf16 v[64:79], v[244:247], v[28:31], v[64:79]
    ds_read_b64_tr_b16 v[44:45], v9 offset:26624
    ds_read_b64_tr_b16 v[46:47], v9 offset:27136
    v_cndmask_b32 v80, 0, v100, s[72:73]
    v_cndmask_b32 v84, v100, 0, s[72:73]
    v_cndmask_b32 v81, 0, v101, s[72:73]
    v_cndmask_b32 v85, v101, 0, s[72:73]
    v_cndmask_b32 v82, 0, v102, s[72:73]
    v_cndmask_b32 v86, v102, 0, s[72:73]
    v_cndmask_b32 v83, 0, v103, s[72:73]
    v_cndmask_b32 v87, v103, 0, s[72:73]
    s_waitcnt lgkmcnt(5)
    v_mfma_f32_32x32x16_bf16 v[48:63], v[32:35], v[248:251], v[48:63]
    s_waitcnt lgkmcnt(0)
    v_mfma_f32_32x32x16_bf16 v[48:63], v[40:43], v[252:255], v[48:63]
    v_mfma_f32_32x32x16_bf16 v[64:79], v[248:251], v[36:39], v[64:79]
    v_mfma_f32_32x32x16_bf16 v[64:79], v[252:255], v[44:47], v[64:79]
    v_mov_b64 v[120:121], -1
    v_mov_b64 v[122:123], -1
    buffer_store_dwordx4 v[120:123], v15, s[52:55], s77 offen sc1
    buffer_store_dwordx4 v[120:123], v15, s[52:55], s77 offen offset:1024 sc1
    s_cmp_lg_u32 s3, 7
    s_cbranch_scc1 A_cl
    buffer_load_dword v13, off, s[56:59], 0 offset:128 sc1
A_cl:
    s_mov_b32 s65, 0
    s_mov_b32 s74, 0x3fb8aa3b
    s_mov_b32 s75, s74
A_phi:
    s_nop 3
    v_cvt_pk_bf16_f32 v112, v48, v49
    v_cvt_pk_bf16_f32 v113, v50, v51
    v_cvt_pk_bf16_f32 v114, v52, v53
    v_cvt_pk_bf16_f32 v115, v54, v55
    v_cvt_pk_bf16_f32 v116, v56, v57
    v_cvt_pk_bf16_f32 v117, v58, v59
    v_cvt_pk_bf16_f32 v118, v60, v61
    v_cvt_pk_bf16_f32 v119, v62, v63
    v_mfma_f32_32x32x16_bf16 v[48:63], v[80:83], v[112:115], 0
    s_nop 0
    v_mfma_f32_32x32x16_bf16 v[48:63], v[84:87], v[116:119], v[48:63]
    s_nop 11
    v_max3_f32 v96, v48, v49, v50
    v_min3_f32 v98, v48, v49, v50
    v_max3_f32 v96, v96, v51, v52
    v_min3_f32 v98, v98, v51, v52
    v_max3_f32 v96, v96, v53, v54
    v_min3_f32 v98, v98, v53, v54
    v_max3_f32 v96, v96, v55, v56
    v_min3_f32 v98, v98, v55, v56
    v_max3_f32 v96, v96, v57, v58
    v_min3_f32 v98, v98, v57, v58
    v_max3_f32 v96, v96, v59, v60
    v_min3_f32 v98, v98, v59, v60
    v_max3_f32 v96, v96, v61, v62
    v_min3_f32 v98, v98, v61, v62
    v_max_f32 v96, v96, v63
    v_min_f32 v98, v98, v63
    v_mul_f32 v96, s74, v96
    v_mul_f32 v98, s74, v98
    v_pk_fma_f32 v[16:17], v[48:49], s[74:75], v[96:97] op_sel_hi:[1,1,0] neg_lo:[0,0,1] neg_hi:[0,0,1]
    v_pk_fma_f32 v[32:33], v[48:49], s[74:75], v[98:99] op_sel_hi:[1,1,0] neg_lo:[1,0,0] neg_hi:[1,0,0]
    v_pk_fma_f32 v[18:19], v[50:51], s[74:75], v[96:97] op_sel_hi:[1,1,0] neg_lo:[0,0,1] neg_hi:[0,0,1]
    v_pk_fma_f32 v[34:35], v[50:51], s[74:75], v[98:99] op_sel_hi:[1,1,0] neg_lo:[1,0,0] neg_hi:[1,0,0]
    v_pk_fma_f32 v[20:21], v[52:53], s[74:75], v[96:97] op_sel_hi:[1,1,0] neg_lo:[0,0,1] neg_hi:[0,0,1]
    v_pk_fma_f32 v[36:37], v[52:53], s[74:75], v[98:99] op_sel_hi:[1,1,0] neg_lo:[1,0,0] neg_hi:[1,0,0]
    v_pk_fma_f32 v[22:23], v[54:55], s[74:75], v[96:97] op_sel_hi:[1,1,0] neg_lo:[0,0,1] neg_hi:[0,0,1]
    v_pk_fma_f32 v[38:39], v[54:55], s[74:75], v[98:99] op_sel_hi:[1,1,0] neg_lo:[1,0,0] neg_hi:[1,0,0]
    v_pk_fma_f32 v[24:25], v[56:57], s[74:75], v[96:97] op_sel_hi:[1,1,0] neg_lo:[0,0,1] neg_hi:[0,0,1]
    v_pk_fma_f32 v[40:41], v[56:57], s[74:75], v[98:99] op_sel_hi:[1,1,0] neg_lo:[1,0,0] neg_hi:[1,0,0]
    v_pk_fma_f32 v[26:27], v[58:59], s[74:75], v[96:97] op_sel_hi:[1,1,0] neg_lo:[0,0,1] neg_hi:[0,0,1]
    v_pk_fma_f32 v[42:43], v[58:59], s[74:75], v[98:99] op_sel_hi:[1,1,0] neg_lo:[1,0,0] neg_hi:[1,0,0]
    v_pk_fma_f32 v[28:29], v[60:61], s[74:75], v[96:97] op_sel_hi:[1,1,0] neg_lo:[0,0,1] neg_hi:[0,0,1]
    v_pk_fma_f32 v[44:45], v[60:61], s[74:75], v[98:99] op_sel_hi:[1,1,0] neg_lo:[1,0,0] neg_hi:[1,0,0]
    v_pk_fma_f32 v[30:31], v[62:63], s[74:75], v[96:97] op_sel_hi:[1,1,0] neg_lo:[0,0,1] neg_hi:[0,0,1]
    v_pk_fma_f32 v[46:47], v[62:63], s[74:75], v[98:99] op_sel_hi:[1,1,0] neg_lo:[1,0,0] neg_hi:[1,0,0]
    v_exp_f32 v16, v16
    v_exp_f32 v17, v17
    v_exp_f32 v18, v18
    v_exp_f32 v19, v19
    v_exp_f32 v20, v20
    v_exp_f32 v21, v21
    v_exp_f32 v22, v22
    v_exp_f32 v23, v23
    v_exp_f32 v24, v24
    v_exp_f32 v25, v25
    v_exp_f32 v26, v26
    v_exp_f32 v27, v27
    v_exp_f32 v28, v28
    v_exp_f32 v29, v29
    v_exp_f32 v30, v30
    v_exp_f32 v31, v31
    v_exp_f32 v32, v32
    v_exp_f32 v33, v33
    v_exp_f32 v34, v34
    v_exp_f32 v35, v35
    v_exp_f32 v36, v36
    v_exp_f32 v37, v37
    v_exp_f32 v38, v38
    v_exp_f32 v39, v39
    v_exp_f32 v40, v40
    v_exp_f32 v41, v41
    v_exp_f32 v42, v42
    v_exp_f32 v43, v43
    v_exp_f32 v44, v44
    v_exp_f32 v45, v45
    v_exp_f32 v46, v46
    v_exp_f32 v47, v47
    v_pk_add_f32 v[48:49], v[16:17], v[18:19]
    v_pk_add_f32 v[50:51], v[32:33], v[34:35]
    v_pk_add_f32 v[48:49], v[48:49], v[20:21]
    v_pk_add_f32 v[50:51], v[50:51], v[36:37]
    v_pk_add_f32 v[48:49], v[48:49], v[22:23]
    v_pk_add_f32 v[50:51], v[50:51], v[38:39]
    v_pk_add_f32 v[48:49], v[48:49], v[24:25]
    v_pk_add_f32 v[50:51], v[50:51], v[40:41]
    v_pk_add_f32 v[48:49], v[48:49], v[26:27]
    v_pk_add_f32 v[50:51], v[50:51], v[42:43]
    v_pk_add_f32 v[48:49], v[48:49], v[28:29]
    v_pk_add_f32 v[50:51], v[50:51], v[44:45]
    v_pk_add_f32 v[48:49], v[48:49], v[30:31]
    v_pk_add_f32 v[50:51], v[50:51], v[46:47]
    v_add_f32 v48, v48, v49
    v_add_f32 v50, v50, v51
    v_rcp_f32 v48, v48
    v_rcp_f32 v50, v50
    v_pk_mul_f32 v[16:17], v[16:17], v[48:49] op_sel_hi:[1,0]
    v_pk_mul_f32 v[18:19], v[18:19], v[48:49] op_sel_hi:[1,0]
    v_pk_mul_f32 v[20:21], v[20:21], v[48:49] op_sel_hi:[1,0]
    v_pk_mul_f32 v[22:23], v[22:23], v[48:49] op_sel_hi:[1,0]
    v_pk_mul_f32 v[24:25], v[24:25], v[48:49] op_sel_hi:[1,0]
    v_pk_mul_f32 v[26:27], v[26:27], v[48:49] op_sel_hi:[1,0]
    v_pk_mul_f32 v[28:29], v[28:29], v[48:49] op_sel_hi:[1,0]
    v_pk_mul_f32 v[30:31], v[30:31], v[48:49] op_sel_hi:[1,0]
    v_pk_mul_f32 v[32:33], v[32:33], v[50:51] op_sel_hi:[1,0]
    v_pk_mul_f32 v[34:35], v[34:35], v[50:51] op_sel_hi:[1,0]
    v_pk_mul_f32 v[36:37], v[36:37], v[50:51] op_sel_hi:[1,0]
    v_pk_mul_f32 v[38:39], v[38:39], v[50:51] op_sel_hi:[1,0]
    v_pk_mul_f32 v[40:41], v[40:41], v[50:51] op_sel_hi:[1,0]
    v_pk_mul_f32 v[42:43], v[42:43], v[50:51] op_sel_hi:[1,0]
    v_pk_mul_f32 v[44:45], v[44:45], v[50:51] op_sel_hi:[1,0]
    v_pk_mul_f32 v[46:47], v[46:47], v[50:51] op_sel_hi:[1,0]
    v_cvt_pk_bf16_f32 v112, v16, v17
    v_cvt_pk_bf16_f32 v113, v18, v19
    v_cvt_pk_bf16_f32 v114, v20, v21
    v_cvt_pk_bf16_f32 v115, v22, v23
    v_cvt_pk_bf16_f32 v116, v24, v25
    v_cvt_pk_bf16_f32 v117, v26, v27
    v_cvt_pk_bf16_f32 v118, v28, v29
    v_cvt_pk_bf16_f32 v119, v30, v31
    v_cvt_pk_bf16_f32 v120, v32, v33
    v_cvt_pk_bf16_f32 v121, v34, v35
    v_cvt_pk_bf16_f32 v122, v36, v37
    v_cvt_pk_bf16_f32 v123, v38, v39
    v_cvt_pk_bf16_f32 v124, v40, v41
    v_cvt_pk_bf16_f32 v125, v42, v43
    v_cvt_pk_bf16_f32 v126, v44, v45
    v_cvt_pk_bf16_f32 v127, v46, v47
    s_cmp_lg_u32 s65, 0
    s_cbranch_scc1 A_apply
    v_mfma_f32_32x32x16_bf16 v[16:31], v[112:115], v[88:91], 0
    v_mfma_f32_32x32x16_bf16 v[32:47], v[120:123], v[88:91], 0
    v_mfma_f32_32x32x16_bf16 v[16:31], v[116:119], v[92:95], v[16:31]
    v_mfma_f32_32x32x16_bf16 v[32:47], v[124:127], v[92:95], v[32:47]
    v_cvt_pk_bf16_f32 v96, v64, v65
    v_cvt_pk_bf16_f32 v97, v66, v67
    v_cvt_pk_bf16_f32 v98, v68, v69
    v_cvt_pk_bf16_f32 v99, v70, v71
    v_cvt_pk_bf16_f32 v100, v72, v73
    v_cvt_pk_bf16_f32 v101, v74, v75
    v_cvt_pk_bf16_f32 v102, v76, v77
    v_cvt_pk_bf16_f32 v103, v78, v79
    s_mul_i32 s4, s71, 4352
    s_lshl_b32 s5, s70, 11
    s_add_u32 s5, s5, s4
    v_and_b32 v8, 15, v1
    v_lshlrev_b32 v8, 4, v8
    v_bfe_u32 v7, v1, 4, 1
    v_lshl_add_u32 v5, v7, 10, v8
    v_lshl_add_u32 v5, v12, 8, v5
    v_add_u32 v5, s5, v5
    v_cvt_pk_bf16_f32 v48, v16, v17
    v_cvt_pk_bf16_f32 v49, v18, v19
    v_cvt_pk_bf16_f32 v50, v20, v21
    v_cvt_pk_bf16_f32 v51, v22, v23
    v_cvt_pk_bf16_f32 v52, v24, v25
    v_cvt_pk_bf16_f32 v53, v26, v27
    v_cvt_pk_bf16_f32 v54, v28, v29
    v_cvt_pk_bf16_f32 v55, v30, v31
    v_cvt_pk_bf16_f32 v56, v32, v33
    v_cvt_pk_bf16_f32 v57, v34, v35
    v_cvt_pk_bf16_f32 v58, v36, v37
    v_cvt_pk_bf16_f32 v59, v38, v39
    v_cvt_pk_bf16_f32 v60, v40, v41
    v_cvt_pk_bf16_f32 v61, v42, v43
    v_cvt_pk_bf16_f32 v62, v44, v45
    v_cvt_pk_bf16_f32 v63, v46, v47
    v_mfma_f32_32x32x16_bf16 v[64:79], v[48:51], v[96:99], 0
    v_mfma_f32_32x32x16_bf16 v[112:127], v[56:59], v[96:99], 0
    v_mfma_f32_32x32x16_bf16 v[64:79], v[52:55], v[100:103], v[64:79]
    v_mfma_f32_32x32x16_bf16 v[112:127], v[60:63], v[100:103], v[112:127]
    v_pk_add_f32 v[16:17], v[16:17], v[18:19]
    v_pk_add_f32 v[32:33], v[32:33], v[34:35]
    v_pk_add_f32 v[16:17], v[16:17], v[20:21]
    v_pk_add_f32 v[32:33], v[32:33], v[36:37]
    v_pk_add_f32 v[16:17], v[16:17], v[22:23]
    v_pk_add_f32 v[32:33], v[32:33], v[38:39]
    v_pk_add_f32 v[16:17], v[16:17], v[24:25]
    v_pk_add_f32 v[32:33], v[32:33], v[40:41]
    v_pk_add_f32 v[16:17], v[16:17], v[26:27]
    v_pk_add_f32 v[32:33], v[32:33], v[42:43]
    v_pk_add_f32 v[16:17], v[16:17], v[28:29]
    v_pk_add_f32 v[32:33], v[32:33], v[44:45]
    v_pk_add_f32 v[16:17], v[16:17], v[30:31]
    v_pk_add_f32 v[32:33], v[32:33], v[46:47]
    v_add_f32 v16, v16, v17
    v_add_f32 v32, v32, v33
    s_mov_b32 exec_lo, 0xffff
    s_mov_b32 exec_hi, 0xffff
    v_cvt_pk_bf16_f32 v20, v64, v65
    v_cvt_pk_bf16_f32 v21, v66, v67
    v_cvt_pk_bf16_f32 v22, v72, v73
    v_cvt_pk_bf16_f32 v23, v74, v75
    v_cvt_pk_bf16_f32 v24, v112, v113
    v_cvt_pk_bf16_f32 v25, v114, v115
    v_cvt_pk_bf16_f32 v26, v120, v121
    v_cvt_pk_bf16_f32 v27, v122, v123
    s_not_b64 exec, exec
    v_cvt_pk_bf16_f32 v20, v68, v69
    v_cvt_pk_bf16_f32 v21, v70, v71
    v_cvt_pk_bf16_f32 v22, v76, v77
    v_cvt_pk_bf16_f32 v23, v78, v79
    v_cvt_pk_bf16_f32 v24, v116, v117
    v_cvt_pk_bf16_f32 v25, v118, v119
    v_cvt_pk_bf16_f32 v26, v124, v125
    v_cvt_pk_bf16_f32 v27, v126, v127
    s_mov_b64 exec, -1
    ds_write_b128 v5, v[20:23]
    ds_write_b128 v5, v[24:27] offset:512
    v_permlane32_swap_b32 v16, v32
    s_lshl_b32 s5, s70, 7
    s_add_u32 s5, s5, s4
    v_and_b32 v6, 3, v1
    v_lshl_add_u32 v6, v7, 2, v6
    v_add_f32 v16, v16, v32
    v_bfe_u32 v7, v1, 2, 1
    v_lshl_add_u32 v6, v7, 3, v6
    v_lshl_add_u32 v6, v12, 4, v6
    v_bfe_u32 v7, v1, 3, 1
    v_lshl_add_u32 v6, v7, 5, v6
    v_lshl_add_u32 v6, v6, 1, s5
    v_cvt_pk_bf16_f32 v16, v16, v16
    ds_write_b16 v6, v16 offset:4096
    v_lshrrev_b32 v7, 4, v1
    v_mul_u32_u24 v2, 4352, v7
    s_lshl_b32 s4, s3, 9
    v_add_u32 v8, s4, v8
    v_add_u32 v2, v2, v8
    v_lshl_add_u32 v8, v12, 8, v8
    v_and_b32 v7, 1, v7
    v_lshl_add_u32 v8, v7, 9, v8
    s_cmp_lg_u32 s3, 7
    s_cbranch_scc1 A_cc_done
    s_mov_b32 s5, 0
A_cc_loop:
    s_waitcnt vmcnt(0)
    v_readfirstlane_b32 s4, v13
    s_add_u32 s5, s5, 1
    s_cmp_lg_u32 s4, 0
    s_cbranch_scc1 A_cc_done
    buffer_load_dword v13, off, s[56:59], 0 offset:128 sc1
    s_cmp_lt_u32 s5, 0x40000
    s_cbranch_scc1 A_cc_loop
A_cc_done:
    s_cmp_eq_u32 s3, 7
    s_cselect_b32 s5, -1, 0xffff
    s_waitcnt vmcnt(0) lgkmcnt(0)
    s_barrier
    v_add_u32 v9, 0x8000, v9
    ds_read_b128 v[96:99], v2
    ds_read_b128 v[100:103], v2 offset:256
    ds_read_b128 v[112:115], v2 offset:512
    ds_read_b64_tr_b16 v[16:17], v9 offset:0
    ds_read_b64_tr_b16 v[18:19], v9 offset:512
    ds_read_b64_tr_b16 v[20:21], v9 offset:8192
    ds_read_b64_tr_b16 v[22:23], v9 offset:8704
    ds_read_b64_tr_b16 v[24:25], v9 offset:16384
    ds_read_b64_tr_b16 v[26:27], v9 offset:16896
    ds_read_b64_tr_b16 v[28:29], v9 offset:24576
    ds_read_b64_tr_b16 v[30:31], v9 offset:25088
    s_waitcnt lgkmcnt(9)
    v_mfma_f32_16x16x32_bf16 v[116:119], v[104:107], v[96:99], 0
    v_mfma_f32_16x16x32_bf16 v[116:119], v[108:111], v[100:103], v[116:119]
    s_waitcnt lgkmcnt(8)
    v_mfma_f32_16x16x32_bf16 v[120:123], v[104:107], v[112:115], 0
    s_nop 5
    v_cvt_pk_bf16_f32 v64, v116, v117
    v_cvt_pk_bf16_f32 v65, v118, v119
    v_cvt_pk_bf16_f32 v66, v120, v121
    v_cvt_pk_bf16_f32 v67, v122, v123
    s_nop 0
    v_permlane16_swap_b32 v64, v66
    v_permlane16_swap_b32 v65, v67
    s_mov_b32 exec_lo, s5
    s_mov_b32 exec_hi, 0xffff
    buffer_store_dwordx4 v[64:67], v8, s[52:55], s76 offen sc1
    s_mov_b64 exec, -1
    ds_read_b64_tr_b16 v[32:33], v9 offset:1024
    ds_read_b64_tr_b16 v[34:35], v9 offset:1536
    ds_read_b64_tr_b16 v[36:37], v9 offset:9216
    ds_read_b64_tr_b16 v[38:39], v9 offset:9728
    ds_read_b64_tr_b16 v[40:41], v9 offset:17408
    ds_read_b64_tr_b16 v[42:43], v9 offset:17920
    ds_read_b64_tr_b16 v[44:45], v9 offset:25600
    ds_read_b64_tr_b16 v[46:47], v9 offset:26112
    s_waitcnt lgkmcnt(8)
    v_mfma_f32_32x32x16_bf16 v[48:63], v[16:19], v[128:131], 0
    v_mfma_f32_32x32x16_bf16 v[48:63], v[20:23], v[132:135], v[48:63]
    s_add_u32 m0, s64, 32768
    s_mov_b32 s4, 0
    buffer_load_dwordx4 v14, s[44:47], s4 offen offset:0 lds
    v_mfma_f32_32x32x16_bf16 v[48:63], v[24:27], v[136:139], v[48:63]
    v_mfma_f32_32x32x16_bf16 v[48:63], v[28:31], v[140:143], v[48:63]
    s_mov_b32 s4, 64512
    buffer_load_dwordx4 v14, s[44:47], s4 offen offset:1024 lds
    ds_read_b64_tr_b16 v[16:17], v9 offset:2048
    ds_read_b64_tr_b16 v[18:19], v9 offset:2560
    ds_read_b64_tr_b16 v[20:21], v9 offset:10240
    ds_read_b64_tr_b16 v[22:23], v9 offset:10752
    ds_read_b64_tr_b16 v[24:25], v9 offset:18432
    ds_read_b64_tr_b16 v[26:27], v9 offset:18944
    ds_read_b64_tr_b16 v[28:29], v9 offset:26624
    ds_read_b64_tr_b16 v[30:31], v9 offset:27136
    s_waitcnt lgkmcnt(8)
    v_mfma_f32_32x32x16_bf16 v[48:63], v[32:35], v[144:147], v[48:63]
    v_mfma_f32_32x32x16_bf16 v[48:63], v[36:39], v[148:151], v[48:63]
    s_mov_b32 s4, 129024
    buffer_load_dwordx4 v14, s[44:47], s4 offen offset:2048 lds
    v_mfma_f32_32x32x16_bf16 v[48:63], v[40:43], v[152:155], v[48:63]
    v_mfma_f32_32x32x16_bf16 v[48:63], v[44:47], v[156:159], v[48:63]
    s_mov_b32 s4, 193536
    buffer_load_dwordx4 v14, s[44:47], s4 offen offset:3072 lds
    ds_read_b64_tr_b16 v[32:33], v9 offset:3072
    ds_read_b64_tr_b16 v[34:35], v9 offset:3584
    ds_read_b64_tr_b16 v[36:37], v9 offset:11264
    ds_read_b64_tr_b16 v[38:39], v9 offset:11776
    ds_read_b64_tr_b16 v[40:41], v9 offset:19456
    ds_read_b64_tr_b16 v[42:43], v9 offset:19968
    ds_read_b64_tr_b16 v[44:45], v9 offset:27648
    ds_read_b64_tr_b16 v[46:47], v9 offset:28160
    s_waitcnt lgkmcnt(8)
    v_mfma_f32_32x32x16_bf16 v[48:63], v[16:19], v[160:163], v[48:63]
    v_mfma_f32_32x32x16_bf16 v[48:63], v[20:23], v[164:167], v[48:63]
    s_add_u32 m0, s64, 65536
    s_mov_b32 s4, 262144
    buffer_load_dwordx4 v14, s[44:47], s4 offen offset:0 lds
    v_mfma_f32_32x32x16_bf16 v[48:63], v[24:27], v[168:171], v[48:63]
    v_mfma_f32_32x32x16_bf16 v[48:63], v[28:31], v[172:175], v[48:63]
    s_mov_b32 s4, 326656
    buffer_load_dwordx4 v14, s[44:47], s4 offen offset:1024 lds
    ds_read_b64_tr_b16 v[16:17], v9 offset:32768
    ds_read_b64_tr_b16 v[18:19], v9 offset:33280
    ds_read_b64_tr_b16 v[20:21], v9 offset:40960
    ds_read_b64_tr_b16 v[22:23], v9 offset:41472
    ds_read_b64_tr_b16 v[24:25], v9 offset:49152
    ds_read_b64_tr_b16 v[26:27], v9 offset:49664
    ds_read_b64_tr_b16 v[28:29], v9 offset:57344
    ds_read_b64_tr_b16 v[30:31], v9 offset:57856
    s_waitcnt lgkmcnt(8)
    v_mfma_f32_32x32x16_bf16 v[48:63], v[32:35], v[176:179], v[48:63]
    v_mfma_f32_32x32x16_bf16 v[48:63], v[36:39], v[180:183], v[48:63]
    s_mov_b32 s4, 391168
    buffer_load_dwordx4 v14, s[44:47], s4 offen offset:2048 lds
    v_mfma_f32_32x32x16_bf16 v[48:63], v[40:43], v[184:187], v[48:63]
    v_mfma_f32_32x32x16_bf16 v[48:63], v[44:47], v[188:191], v[48:63]
    s_mov_b32 s4, 455680
    buffer_load_dwordx4 v14, s[44:47], s4 offen offset:3072 lds
    ds_read_b64_tr_b16 v[32:33], v9 offset:33792
    ds_read_b64_tr_b16 v[34:35], v9 offset:34304
    ds_read_b64_tr_b16 v[36:37], v9 offset:41984
    ds_read_b64_tr_b16 v[38:39], v9 offset:42496
    ds_read_b64_tr_b16 v[40:41], v9 offset:50176
    ds_read_b64_tr_b16 v[42:43], v9 offset:50688
    ds_read_b64_tr_b16 v[44:45], v9 offset:58368
    ds_read_b64_tr_b16 v[46:47], v9 offset:58880
    s_waitcnt lgkmcnt(8)
    v_mfma_f32_32x32x16_bf16 v[48:63], v[16:19], v[192:195], v[48:63]
    v_mfma_f32_32x32x16_bf16 v[48:63], v[20:23], v[196:199], v[48:63]
    s_and_b32 s4, s3, 6
    s_lshr_b32 s5, s66, 1
    s_lshl4_add_u32 s4, s4, s5
    s_mul_i32 s69, s4, 4352
    v_mul_u32_u24 v184, 69632, v12
    v_mfma_f32_32x32x16_bf16 v[48:63], v[24:27], v[200:203], v[48:63]
    s_mul_i32 s76, s63, 69632
    s_add_u32 s78, s76, 17408
    s_add_u32 s79, s76, 34816
    s_add_u32 s24, s76, 52224
    v_and_b32 v5, 15, v1
    v_mfma_f32_32x32x16_bf16 v[48:63], v[28:31], v[204:207], v[48:63]
    v_lshlrev_b32 v7, 3, v7
    v_mul_u32_u24 v3, 272, v5
    v_add_u32 v3, v3, v7
    v_lshl_add_u32 v6, s3, 1, v12
    v_mul_u32_u24 v6, 272, v6
    ds_read_b64_tr_b16 v[16:17], v9 offset:34816
    ds_read_b64_tr_b16 v[18:19], v9 offset:35328
    ds_read_b64_tr_b16 v[20:21], v9 offset:43008
    ds_read_b64_tr_b16 v[22:23], v9 offset:43520
    ds_read_b64_tr_b16 v[24:25], v9 offset:51200
    ds_read_b64_tr_b16 v[26:27], v9 offset:51712
    ds_read_b64_tr_b16 v[28:29], v9 offset:59392
    ds_read_b64_tr_b16 v[30:31], v9 offset:59904
    s_waitcnt lgkmcnt(8)
    v_mfma_f32_32x32x16_bf16 v[48:63], v[32:35], v[208:211], v[48:63]
    v_lshl_add_u32 v6, v5, 4, v6
    v_add_u32 v6, v6, v7
    v_and_b32 v4, 31, v1
    v_min_u32 v4, 16, v4
    v_lshlrev_b32 v4, 4, v4
    v_mfma_f32_32x32x16_bf16 v[48:63], v[36:39], v[212:215], v[48:63]
    v_lshl_add_u32 v5, s70, 3, v12
    v_mul_u32_u24 v5, 272, v5
    v_add_u32 v4, v4, v5
    v_mov_b32 v180, 0
    v_mfma_f32_32x32x16_bf16 v[48:63], v[40:43], v[216:219], v[48:63]
    buffer_load_dword v185, v184, s[52:55], s69 offen sc1
    v_mfma_f32_32x32x16_bf16 v[48:63], v[44:47], v[220:223], v[48:63]
    s_cmp_lg_u32 s3, 7
    s_cbranch_scc1 A_p0a
    buffer_load_dwordx4 v[160:163], v2, s[52:55], s76 offen offset:512 sc1
    buffer_load_dwordx4 v[164:167], v2, s[52:55], s78 offen offset:512 sc1
    buffer_load_dwordx4 v[168:171], v2, s[52:55], s79 offen offset:512 sc1
    buffer_load_dwordx4 v[172:175], v2, s[52:55], s24 offen offset:512 sc1
A_p0a:
    ds_read_b64_tr_b16 v[32:33], v9 offset:35840
    ds_read_b64_tr_b16 v[34:35], v9 offset:36352
    ds_read_b64_tr_b16 v[36:37], v9 offset:44032
    ds_read_b64_tr_b16 v[38:39], v9 offset:44544
    ds_read_b64_tr_b16 v[40:41], v9 offset:52224
    ds_read_b64_tr_b16 v[42:43], v9 offset:52736
    ds_read_b64_tr_b16 v[44:45], v9 offset:60416
    ds_read_b64_tr_b16 v[46:47], v9 offset:60928
    s_waitcnt lgkmcnt(8)
    v_mfma_f32_32x32x16_bf16 v[48:63], v[16:19], v[224:227], v[48:63]
    buffer_load_dwordx4 v[128:131], v2, s[52:55], s76 offen offset:0 sc1
    v_mfma_f32_32x32x16_bf16 v[48:63], v[20:23], v[228:231], v[48:63]
    buffer_load_dwordx4 v[132:135], v2, s[52:55], s76 offen offset:256 sc1
    v_mfma_f32_32x32x16_bf16 v[48:63], v[24:27], v[232:235], v[48:63]
    buffer_load_dwordx4 v[136:139], v2, s[52:55], s78 offen offset:0 sc1
    v_mfma_f32_32x32x16_bf16 v[48:63], v[28:31], v[236:239], v[48:63]
    buffer_load_dwordx4 v[140:143], v2, s[52:55], s78 offen offset:256 sc1
    s_waitcnt lgkmcnt(0)
    v_mfma_f32_32x32x16_bf16 v[48:63], v[32:35], v[240:243], v[48:63]
    buffer_load_dwordx4 v[144:147], v2, s[52:55], s79 offen offset:0 sc1
    v_mfma_f32_32x32x16_bf16 v[48:63], v[36:39], v[244:247], v[48:63]
    buffer_load_dwordx4 v[148:151], v2, s[52:55], s79 offen offset:256 sc1
    v_mfma_f32_32x32x16_bf16 v[48:63], v[40:43], v[248:251], v[48:63]
    buffer_load_dwordx4 v[152:155], v2, s[52:55], s24 offen offset:0 sc1
    v_mfma_f32_32x32x16_bf16 v[48:63], v[44:47], v[252:255], v[48:63]
    buffer_load_dwordx4 v[156:159], v2, s[52:55], s24 offen offset:256 sc1
    s_add_u32 s65, s70, 2
    s_nop 5
    s_branch A_phi
A_apply:
    v_permlane32_swap_b32 v112, v116
    v_permlane32_swap_b32 v120, v124
    v_permlane32_swap_b32 v113, v117
    v_permlane32_swap_b32 v121, v125
    v_permlane32_swap_b32 v114, v118
    v_permlane32_swap_b32 v122, v126
    v_permlane32_swap_b32 v115, v119
    v_permlane32_swap_b32 v123, v127
    s_branch A_p1w
A_p1:
    buffer_load_dword v185, v184, s[52:55], s69 offen sc1
    s_cmp_lg_u32 s3, 7
    s_cbranch_scc1 A_p1a
    buffer_load_dwordx4 v[160:163], v2, s[52:55], s76 offen offset:512 sc1
    buffer_load_dwordx4 v[164:167], v2, s[52:55], s78 offen offset:512 sc1
    buffer_load_dwordx4 v[168:171], v2, s[52:55], s79 offen offset:512 sc1
    buffer_load_dwordx4 v[172:175], v2, s[52:55], s24 offen offset:512 sc1
A_p1a:
    buffer_load_dwordx4 v[128:131], v2, s[52:55], s76 offen offset:0 sc1
    buffer_load_dwordx4 v[132:135], v2, s[52:55], s76 offen offset:256 sc1
    buffer_load_dwordx4 v[136:139], v2, s[52:55], s78 offen offset:0 sc1
    buffer_load_dwordx4 v[140:143], v2, s[52:55], s78 offen offset:256 sc1
    buffer_load_dwordx4 v[144:147], v2, s[52:55], s79 offen offset:0 sc1
    buffer_load_dwordx4 v[148:151], v2, s[52:55], s79 offen offset:256 sc1
    buffer_load_dwordx4 v[152:155], v2, s[52:55], s24 offen offset:0 sc1
    buffer_load_dwordx4 v[156:159], v2, s[52:55], s24 offen offset:256 sc1
A_p1w:
    s_cmp_lg_u32 s3, 7
    s_cbranch_scc1 A_p1b
    s_waitcnt vmcnt(8)
    v_mfma_f32_16x16x32_bf16 v[180:183], v[104:107], v[160:163], 0
    v_mfma_f32_16x16x32_bf16 v[180:183], v[104:107], v[164:167], v[180:183]
    v_mfma_f32_16x16x32_bf16 v[180:183], v[104:107], v[168:171], v[180:183]
    v_mfma_f32_16x16x32_bf16 v[180:183], v[104:107], v[172:175], v[180:183]
A_p1b:
    s_waitcnt vmcnt(7)
    v_mfma_f32_16x16x32_bf16 v[176:179], v[104:107], v[128:131], 0
    s_waitcnt vmcnt(6)
    v_mfma_f32_16x16x32_bf16 v[176:179], v[108:111], v[132:135], v[176:179]
    s_waitcnt vmcnt(5)
    v_mfma_f32_16x16x32_bf16 v[176:179], v[104:107], v[136:139], v[176:179]
    s_waitcnt vmcnt(4)
    v_mfma_f32_16x16x32_bf16 v[176:179], v[108:111], v[140:143], v[176:179]
    s_waitcnt vmcnt(3)
    v_mfma_f32_16x16x32_bf16 v[176:179], v[104:107], v[144:147], v[176:179]
    s_waitcnt vmcnt(2)
    v_mfma_f32_16x16x32_bf16 v[176:179], v[108:111], v[148:151], v[176:179]
    s_waitcnt vmcnt(1)
    v_mfma_f32_16x16x32_bf16 v[176:179], v[104:107], v[152:155], v[176:179]
    s_waitcnt vmcnt(0)
    v_mfma_f32_16x16x32_bf16 v[176:179], v[108:111], v[156:159], v[176:179]
    s_add_u32 s65, s65, 1
    s_cmp_lt_u32 s65, 0x4000
    s_cselect_b64 s[4:5], -1, 0
    v_cmp_eq_u32 s[6:7], -1, v185
    s_nop 3
    v_cmp_u_f32 vcc, v176, v180
    v_cvt_pk_bf16_f32 v186, v176, v177
    v_cvt_pk_bf16_f32 v187, v178, v179
    s_or_b64 vcc, vcc, s[6:7]
    s_and_b64 vcc, vcc, s[4:5]
    s_cbranch_scc1 A_p1
    ds_write_b64 v6, v[186:187] offset:20480
    s_cmp_lg_u32 s3, 7
    s_cbranch_scc1 A_p1c
    v_cvt_pk_bf16_f32 v188, v180, v181
    v_cvt_pk_bf16_f32 v189, v182, v183
    s_mov_b32 exec_hi, 0
    ds_write_b64 v3, v[188:189] offset:20736
    s_mov_b32 exec_hi, -1
A_p1c:
    s_waitcnt lgkmcnt(0)
    s_barrier
    ds_read_b128 v[128:131], v4 offset:20480
    ds_read_b128 v[132:135], v4 offset:21024
    ds_read_b128 v[136:139], v4 offset:21568
    ds_read_b128 v[140:143], v4 offset:22112
    s_waitcnt lgkmcnt(3)
    v_mfma_f32_32x32x16_bf16 v[16:31], v[128:131], v[112:115], 0
    s_waitcnt lgkmcnt(2)
    v_mfma_f32_32x32x16_bf16 v[16:31], v[132:135], v[120:123], v[16:31]
    s_waitcnt lgkmcnt(1)
    v_mfma_f32_32x32x16_bf16 v[32:47], v[136:139], v[116:119], 0
    s_waitcnt lgkmcnt(0)
    v_mfma_f32_32x32x16_bf16 v[32:47], v[140:143], v[124:127], v[32:47]
    s_mov_b32 s65, 32768
    s_nop 6
    v_add_f32 v24, 0x358637bd, v24
    v_rcp_f32 v24, v24
    s_nop 0
    v_pk_mul_f32 v[16:17], v[16:17], v[24:25] op_sel_hi:[1,0]
    v_pk_mul_f32 v[18:19], v[18:19], v[24:25] op_sel_hi:[1,0]
    v_pk_mul_f32 v[20:21], v[20:21], v[24:25] op_sel_hi:[1,0]
    v_pk_mul_f32 v[22:23], v[22:23], v[24:25] op_sel_hi:[1,0]
    v_cvt_pk_bf16_f32 v48, v16, v17
    v_cvt_pk_bf16_f32 v49, v18, v19
    v_cvt_pk_bf16_f32 v50, v20, v21
    v_cvt_pk_bf16_f32 v51, v22, v23
    buffer_store_dwordx4 v[48:51], v15, s[52:55], s77 offen offset:0 sc1
    v_add_f32 v40, 0x358637bd, v40
    v_rcp_f32 v40, v40
    s_nop 0
    v_pk_mul_f32 v[32:33], v[32:33], v[40:41] op_sel_hi:[1,0]
    v_pk_mul_f32 v[34:35], v[34:35], v[40:41] op_sel_hi:[1,0]
    v_pk_mul_f32 v[36:37], v[36:37], v[40:41] op_sel_hi:[1,0]
    v_pk_mul_f32 v[38:39], v[38:39], v[40:41] op_sel_hi:[1,0]
    v_cvt_pk_bf16_f32 v52, v32, v33
    v_cvt_pk_bf16_f32 v53, v34, v35
    v_cvt_pk_bf16_f32 v54, v36, v37
    v_cvt_pk_bf16_f32 v55, v38, v39
    buffer_store_dwordx4 v[52:55], v15, s[52:55], s77 offen offset:1024 sc1
OUTP:
    s_and_b32 s6, s3, 1
    s_lshr_b32 s7, s3, 1
    s_lshl1_add_u32 s4, s66, s6
    s_lshl2_add_u32 s4, s4, s7
    s_lshl_b32 s4, s4, 13
    s_add_u32 s78, s4, 1048576
    s_add_u32 s79, s78, 4096
    v_mov_b32 v64, s67
    v_and_b32 v64, 1, v64
    v_lshlrev_b32 v64, 12, v64
    s_lshr_b32 s4, s3, 2
    s_lshl_b32 s4, s4, 15
    s_bfe_u32 s5, s3, 0x10001
    s_lshl_b32 s5, s5, 11
    s_add_u32 s4, s4, s5
    s_add_u32 s4, s4, s65
    v_lshl_add_u32 v2, v12, 9, v10
    v_and_b32 v3, 1, v1
    v_lshl_add_u32 v2, v3, 4, v2
    v_and_b32 v3, 2, v1
    v_lshlrev_b32 v3, 2, v3
    v_add3_u32 v2, v2, v3, s4
    v_xor_b32 v3, 64, v2
    ds_read_b64_tr_b16 v[128:129], v2 offset:0
    ds_read_b64_tr_b16 v[130:131], v2 offset:4096
    ds_read_b64_tr_b16 v[132:133], v3 offset:0
    ds_read_b64_tr_b16 v[134:135], v3 offset:4096
    ds_read_b64_tr_b16 v[136:137], v2 offset:8192
    ds_read_b64_tr_b16 v[138:139], v2 offset:12288
    ds_read_b64_tr_b16 v[140:141], v3 offset:8192
    ds_read_b64_tr_b16 v[142:143], v3 offset:12288
    ds_read_b64_tr_b16 v[144:145], v2 offset:16384
    ds_read_b64_tr_b16 v[146:147], v2 offset:20480
    ds_read_b64_tr_b16 v[148:149], v3 offset:16384
    ds_read_b64_tr_b16 v[150:151], v3 offset:20480
    ds_read_b64_tr_b16 v[152:153], v2 offset:24576
    ds_read_b64_tr_b16 v[154:155], v2 offset:28672
    ds_read_b64_tr_b16 v[156:157], v3 offset:24576
    ds_read_b64_tr_b16 v[158:159], v3 offset:28672
    ds_read_b64_tr_b16 v[160:161], v2 offset:1024
    ds_read_b64_tr_b16 v[162:163], v2 offset:5120
    ds_read_b64_tr_b16 v[164:165], v3 offset:1024
    ds_read_b64_tr_b16 v[166:167], v3 offset:5120
    ds_read_b64_tr_b16 v[168:169], v2 offset:9216
    ds_read_b64_tr_b16 v[170:171], v2 offset:13312
    ds_read_b64_tr_b16 v[172:173], v3 offset:9216
    ds_read_b64_tr_b16 v[174:175], v3 offset:13312
    ds_read_b64_tr_b16 v[176:177], v2 offset:17408
    ds_read_b64_tr_b16 v[178:179], v2 offset:21504
    ds_read_b64_tr_b16 v[180:181], v3 offset:17408
    ds_read_b64_tr_b16 v[182:183], v3 offset:21504
    ds_read_b64_tr_b16 v[184:185], v2 offset:25600
    ds_read_b64_tr_b16 v[186:187], v2 offset:29696
    ds_read_b64_tr_b16 v[188:189], v3 offset:25600
    ds_read_b64_tr_b16 v[190:191], v3 offset:29696
    v_and_b32 v8, 7, v1
    v_xor_b32 v4, v8, v12
    v_lshlrev_b32 v4, 4, v4
    v_and_b32 v5, 31, v1
    v_lshl_add_u32 v4, v5, 7, v4
    s_add_u32 s4, s64, 131072
    v_add_u32 v4, s4, v4
    v_xor_b32 v5, 32, v4
    v_xor_b32 v6, 64, v4
    v_xor_b32 v7, 0x60, v4
    v_bfe_u32 v9, v1, 3, 1
    v_lshl_add_u32 v9, v12, 1, v9
    v_bfe_u32 v11, v1, 4, 1
    v_lshl_add_u32 v9, v11, 2, v9
    v_xor_b32 v8, v8, v9
    v_lshlrev_b32 v8, 4, v8
    v_lshl_add_u32 v8, v9, 11, v8
    v_lshrrev_b32 v9, 4, v1
    v_lshlrev_b32 v9, 13, v9
    v_and_b32 v11, 0xf0, v15
    s_lshl_b32 s4, s3, 10
    s_add_u32 s4, s4, 131072
    v_add3_u32 v9, v9, v11, s4
    s_lshl3_add_u32 s76, s66, s3
    s_lshl_b32 s76, s76, 14
    s_lshl_b32 s4, s67, 7
    s_add_u32 s76, s76, s4
    s_mov_b32 s65, 0
    s_waitcnt lgkmcnt(0)
O_lp:
    buffer_load_dword v192, v64, s[52:55], s78 offen offset:4080 sc1
    s_add_u32 s65, s65, 1
    s_cmp_lt_u32 s65, 0x4000
    s_cselect_b64 s[4:5], -1, 0
    s_waitcnt vmcnt(0)
    v_cmp_eq_u32 vcc, -1, v192
    s_and_b64 vcc, vcc, s[4:5]
    s_cbranch_scc1 O_lp
    s_mov_b32 s65, 0
O_0:
O_p:
    buffer_load_dwordx4 v[192:195], v15, s[52:55], s78 offen offset:0 sc1
    buffer_load_dwordx4 v[196:199], v15, s[52:55], s78 offen offset:1024 sc1
    buffer_load_dwordx4 v[200:203], v15, s[52:55], s78 offen offset:2048 sc1
    buffer_load_dwordx4 v[204:207], v15, s[52:55], s78 offen offset:3072 sc1
    buffer_load_dwordx4 v[208:211], v15, s[52:55], s79 offen offset:0 sc1
    buffer_load_dwordx4 v[212:215], v15, s[52:55], s79 offen offset:1024 sc1
    buffer_load_dwordx4 v[216:219], v15, s[52:55], s79 offen offset:2048 sc1
    buffer_load_dwordx4 v[220:223], v15, s[52:55], s79 offen offset:3072 sc1
O_w:
    s_waitcnt vmcnt(7)
    v_mfma_f32_32x32x16_bf16 v[16:31], v[128:131], v[192:195], 0
    v_mfma_f32_32x32x16_bf16 v[32:47], v[132:135], v[192:195], 0
    s_waitcnt vmcnt(6)
    v_mfma_f32_32x32x16_bf16 v[16:31], v[136:139], v[196:199], v[16:31]
    v_mfma_f32_32x32x16_bf16 v[32:47], v[140:143], v[196:199], v[32:47]
    s_waitcnt vmcnt(5)
    v_mfma_f32_32x32x16_bf16 v[16:31], v[144:147], v[200:203], v[16:31]
    v_mfma_f32_32x32x16_bf16 v[32:47], v[148:151], v[200:203], v[32:47]
    s_waitcnt vmcnt(4)
    v_mfma_f32_32x32x16_bf16 v[16:31], v[152:155], v[204:207], v[16:31]
    v_mfma_f32_32x32x16_bf16 v[32:47], v[156:159], v[204:207], v[32:47]
    s_waitcnt vmcnt(3)
    v_mfma_f32_32x32x16_bf16 v[16:31], v[160:163], v[208:211], v[16:31]
    v_mfma_f32_32x32x16_bf16 v[32:47], v[164:167], v[208:211], v[32:47]
    s_waitcnt vmcnt(2)
    v_mfma_f32_32x32x16_bf16 v[16:31], v[168:171], v[212:215], v[16:31]
    v_mfma_f32_32x32x16_bf16 v[32:47], v[172:175], v[212:215], v[32:47]
    s_waitcnt vmcnt(1)
    v_mfma_f32_32x32x16_bf16 v[16:31], v[176:179], v[216:219], v[16:31]
    v_mfma_f32_32x32x16_bf16 v[32:47], v[180:183], v[216:219], v[32:47]
    s_waitcnt vmcnt(0)
    v_mfma_f32_32x32x16_bf16 v[16:31], v[184:187], v[220:223], v[16:31]
    v_mfma_f32_32x32x16_bf16 v[32:47], v[188:191], v[220:223], v[32:47]
    s_add_u32 s65, s65, 1
    s_cmp_lt_u32 s65, 0x4000
    s_cselect_b64 s[4:5], -1, 0
    s_nop 7
    v_cmp_u_f32 vcc, v16, v16
    v_cvt_pk_bf16_f32 v48, v16, v17
    v_cvt_pk_bf16_f32 v49, v18, v19
    v_cvt_pk_bf16_f32 v50, v20, v21
    v_cvt_pk_bf16_f32 v51, v22, v23
    s_and_b64 vcc, vcc, s[4:5]
    s_cbranch_scc1 O_p
    ds_write_b128 v4, v[48:51]
    v_cvt_pk_bf16_f32 v52, v24, v25
    v_cvt_pk_bf16_f32 v53, v26, v27
    v_cvt_pk_bf16_f32 v54, v28, v29
    v_cvt_pk_bf16_f32 v55, v30, v31
    ds_write_b128 v5, v[52:55]
    v_cvt_pk_bf16_f32 v56, v32, v33
    v_cvt_pk_bf16_f32 v57, v34, v35
    v_cvt_pk_bf16_f32 v58, v36, v37
    v_cvt_pk_bf16_f32 v59, v38, v39
    ds_write_b128 v6, v[56:59]
    v_cvt_pk_bf16_f32 v60, v40, v41
    v_cvt_pk_bf16_f32 v61, v42, v43
    v_cvt_pk_bf16_f32 v62, v44, v45
    v_cvt_pk_bf16_f32 v63, v46, v47
    ds_write_b128 v7, v[60:63]
    s_cmp_lt_u32 s2, 128
    s_cbranch_scc1 O_ny
    buffer_store_dwordx2 v[230:231], v232, s[48:51], s73 offen offset:2048
O_ny:
    s_waitcnt lgkmcnt(0)
    s_barrier
    ds_read_b128 v[16:19], v9 offset:0
    ds_read_b128 v[20:23], v9 offset:256
    ds_read_b128 v[24:27], v9 offset:512
    ds_read_b128 v[28:31], v9 offset:768
    s_waitcnt lgkmcnt(3)
    v_mfma_f32_16x16x32_bf16 v[32:35], v[104:107], v[16:19], 0
    s_waitcnt lgkmcnt(2)
    v_mfma_f32_16x16x32_bf16 v[32:35], v[108:111], v[20:23], v[32:35]
    s_waitcnt lgkmcnt(1)
    v_mfma_f32_16x16x32_bf16 v[36:39], v[104:107], v[24:27], 0
    s_waitcnt lgkmcnt(0)
    v_mfma_f32_16x16x32_bf16 v[36:39], v[108:111], v[28:31], v[36:39]
    s_nop 3
    v_cvt_pk_bf16_f32 v40, v32, v33
    v_cvt_pk_bf16_f32 v41, v34, v35
    s_nop 1
    v_cvt_pk_bf16_f32 v42, v36, v37
    v_cvt_pk_bf16_f32 v43, v38, v39
    s_nop 0
    v_permlane16_swap_b32 v40, v42
    v_permlane16_swap_b32 v41, v43
    buffer_store_dwordx4 v[40:43], v8, s[48:51], s76 offen
END:
    s_endpgm
BPATH:
    s_load_dwordx2 s[36:37], s[0:1], 40
    s_mov_b32 s38, 131072
    s_mov_b32 s39, 0x20000
    s_load_dwordx2 s[16:17], s[0:1], 72
    s_mov_b32 s18, 1024
    s_mov_b32 s19, 0x20000
    s_load_dwordx2 s[40:41], s[0:1], 48
    s_mov_b32 s42, 131072
    s_mov_b32 s43, 0x20000
    s_load_dwordx2 s[8:9], s[0:1], 56
    s_mov_b32 s10, 131072
    s_mov_b32 s11, 0x20000
    s_load_dwordx2 s[12:13], s[0:1], 64
    s_mov_b32 s14, 131072
    s_mov_b32 s15, 0x20000
    s_load_dwordx2 s[32:33], s[0:1], 32
    s_mov_b32 s34, 2097152
    s_mov_b32 s35, 0x20000
    s_load_dwordx2 s[52:53], s[0:1], 104
    s_mov_b32 s54, 16777216
    s_mov_b32 s55, 0x20000
    s_load_dwordx2 s[44:45], s[0:1], 24
    s_mov_b32 s46, 524288
    s_mov_b32 s47, 0x20000
    s_load_dwordx2 s[48:49], s[0:1], 88
    s_mov_b32 s50, 4194304
    s_mov_b32 s51, 0x20000
    s_load_dwordx2 s[56:57], s[0:1], 96
    s_mov_b32 s58, 256
    s_mov_b32 s59, 0x20000
    s_load_dwordx2 s[28:29], s[0:1], 8
    s_mov_b32 s30, 1572864
    s_mov_b32 s31, 0x20000
    s_load_dwordx2 s[20:21], s[0:1], 80
    s_lshl4_add_u32 s62, s60, s61
    s_sub_u32 s62, s62, 16
    s_lshr_b32 s70, s3, 1
    s_and_b32 s71, s3, 1
    s_lshl_b32 s4, s62, 10
    s_lshl_b32 s63, s62, 3
    s_lshl1_add_u32 s5, s70, s63
    v_lshlrev_b32 v2, 1, v0
    v_lshlrev_b32 v13, 12, v0
    s_getpc_b64 s[6:7]
PCREF:
    s_sub_u32 s6, s6, PCREF-concat_heads__linear_kernel_hedgehog__ssm_conv_s4d__prompt_kernel
    s_subb_u32 s7, s7, 0
    s_and_b32 s24, s61, 15
    s_and_b32 s25, s24, 15
    s_lshl_b32 s25, s25, 10
    v_lshl_add_u32 v4, v0, 1, s25
    v_and_b32 v4, -4, v4
    v_min_u32 v4, CODEEND-concat_heads__linear_kernel_hedgehog__ssm_conv_s4d__prompt_kernel-4, v4
    s_lshl_b32 s24, s24, 17
    s_add_u32 s24, s24, s63
    v_lshrrev_b32 v5, 2, v0
    v_lshlrev_b32 v5, 10, v5
    s_waitcnt lgkmcnt(0)
    buffer_load_ushort v16, v2, s[36:39], s4 offen
    buffer_load_ushort v17, off, s[16:19], s5
    buffer_load_ushort v18, v2, s[40:43], s4 offen
    buffer_load_ushort v32, v2, s[8:11], s4 offen
    buffer_load_ushort v33, v2, s[12:15], s4 offen
    s_barrier
    global_load_dword v238, v4, s[6:7]
    buffer_load_dword v239, v5, s[32:35], s24 offen
    s_mul_i32 s25, s62, 4352
    v_lshlrev_b32 v52, 4, v1
    s_add_u32 s26, s25, 256
    v_mov_b64 v[56:57], -1
    v_mov_b64 v[58:59], -1
    v_lshrrev_b32 v54, 4, v0
    v_mul_u32_u24 v54, 0xc00, v54
    v_and_b32 v55, 15, v0
    v_lshl_add_u32 v54, v55, 5, v54
    s_and_b32 s4, s61, 15
    s_mul_i32 s72, s4, 0x18000
    s_and_b32 s4, s60, 1
    s_lshl_b32 s4, s4, 9
    s_add_u32 s72, s72, s4
    s_load_dwordx2 s[22:23], s[20:21], s63
    s_lshr_b32 s66, s61, 3
    s_lshl2_add_u32 s66, s60, s66
    s_and_b32 s67, s61, 7
    s_lshl_b32 s4, s3, 13
    s_lshl_b32 s5, s67, 7
    s_add_u32 s4, s4, s5
    v_lshrrev_b32 v14, 3, v1
    v_lshlrev_b32 v14, 10, v14
    v_add3_u32 v14, v14, s4, v15
    v_lshrrev_b32 v12, 5, v1
    v_bfe_u32 v9, v1, 2, 2
    v_lshlrev_b32 v9, 7, v9
    v_bfe_u32 v10, v1, 3, 1
    v_lshl_add_u32 v9, v10, 6, v9
    v_bfe_u32 v10, v1, 4, 1
    v_lshl_add_u32 v10, v10, 5, v9
    v_and_b32 v6, 1, v1
    v_lshlrev_b32 v6, 4, v6
    v_mov_b32 v7, 0x3f80
    v_lshlrev_b32 v11, v6, v7
    v_lshlrev_b32 v15, 4, v1
    s_mul_i32 s4, s3, 17408
    v_lshl_add_u32 v2, v1, 2, s4
    v_and_b32 v3, 31, v1
    v_mul_u32_u24 v3, 272, v3
    v_lshlrev_b32 v4, 4, v12
    v_add3_u32 v3, v3, v4, s4
    v_mov_b32 v4, 0x3f80
    ds_write_b32 v2, v4 offset:8704
    s_mov_b32 s74, 0x3fb8aa3b
    s_mov_b32 s75, 0x32a57060
    s_cmp_lg_u32 s3, 7
    s_cbranch_scc1 B_nocl
    buffer_store_dwordx4 v[56:59], v52, s[52:55], s25 offen offset:0 sc1
    buffer_store_dwordx4 v[56:59], v52, s[52:55], s25 offen offset:1024 sc1
    buffer_store_dwordx4 v[56:59], v52, s[52:55], s25 offen offset:2048 sc1
    buffer_store_dwordx4 v[56:59], v52, s[52:55], s25 offen offset:3072 sc1
    buffer_store_dwordx4 v[56:59], v52, s[52:55], s26 offen offset:3072 sc1
    s_waitcnt vmcnt(7)
    s_branch B_cl7
B_nocl:
    s_waitcnt vmcnt(2)
B_cl7:
    v_lshlrev_b32 v16, 16, v16
    v_lshlrev_b32 v17, 16, v17
    v_mul_f32 v20, s74, v16
    v_mul_f32 v21, s74, v17
    v_fma_f32 v22, v16, s74, -v20
    v_fma_f32 v23, v17, s74, -v21
    v_exp_f32 v20, v20
    v_exp_f32 v21, v21
    v_fmac_f32 v22, s75, v16
    v_fmac_f32 v23, s75, v17
    v_mul_f32 v22, 0x3f317218, v22
    v_mul_f32 v23, 0x3f317218, v23
    v_fmac_f32 v20, v22, v20
    v_fmac_f32 v21, v23, v21
    v_cvt_pk_bf16_f32 v16, v20, v21
    v_and_b32 v17, 0xffff0000, v16
    v_lshlrev_b32 v16, 16, v16
    v_mul_f32 v16, v16, v17
    v_lshlrev_b32 v18, 16, v18
    v_lshlrev_b32 v32, 16, v32
    v_lshlrev_b32 v33, 16, v33
    v_mul_f32 v18, v18, v17
    v_add_f32 v17, v17, v17
    v_mul_f32 v16, 0xbfb8aa3b, v16
    v_mul_f32 v18, 0x3e22f983, v18
    v_mul_f32 v32, v32, v17
    v_mul_f32 v33, v33, v17
    buffer_load_dwordx2 v[240:241], v13, s[32:35], s63 offen offset:0
    v_mul_f32 v40, 0x41000000, v16
    v_mul_f32 v41, 0x41000000, v18
    v_mul_f32 v42, 1.0, v16
    v_mul_f32 v43, 1.0, v18
    v_mul_f32 v44, 0x43800000, v16
    v_mul_f32 v45, 0x43800000, v18
    v_fract_f32 v41, v41
    v_exp_f32 v40, v40
    v_fract_f32 v43, v43
    v_exp_f32 v42, v42
    v_fract_f32 v45, v45
    v_exp_f32 v44, v44
    v_cos_f32 v26, v41
    v_sin_f32 v27, v41
    v_cos_f32 v20, v43
    v_sin_f32 v21, v43
    v_cos_f32 v28, v45
    v_sin_f32 v29, v45
    v_pk_mul_f32 v[26:27], v[26:27], v[40:41] op_sel_hi:[1,0]
    v_pk_mul_f32 v[20:21], v[20:21], v[42:43] op_sel_hi:[1,0]
    v_pk_mul_f32 v[28:29], v[28:29], v[44:45] op_sel_hi:[1,0]
    v_mov_b32 v36, v26
    v_cvt_pk_bf16_f32 v47, v32, v33
    buffer_load_dwordx2 v[242:243], v13, s[32:35], s63 offen offset:1024
    v_xor_b32 v37, 0x80000000, v27
    ds_write_b32 v2, v47 offset:0
    v_cvt_pk_bf16_f32 v46, v36, v37
    v_pk_mul_f32 v[40:41], v[20:21], v[20:21] op_sel_hi:[1,0]
    ds_write_b32 v2, v46 offset:8976
    v_pk_fma_f32 v[22:23], v[20:21], v[20:21], v[40:41] op_sel:[1,1,0] op_sel_hi:[0,1,1] neg_lo:[1,0,0]
    v_pk_mul_f32 v[38:39], v[36:37], v[26:27] op_sel_hi:[1,0]
    v_pk_mul_f32 v[40:41], v[22:23], v[22:23] op_sel_hi:[1,0]
    v_pk_fma_f32 v[36:37], v[36:37], v[26:27], v[38:39] op_sel:[1,1,0] op_sel_hi:[0,1,1] neg_hi:[1,0,0]
    v_pk_fma_f32 v[24:25], v[22:23], v[22:23], v[40:41] op_sel:[1,1,0] op_sel_hi:[0,1,1] neg_lo:[1,0,0]
    v_cvt_pk_bf16_f32 v46, v36, v37
    v_pk_mul_f32 v[40:41], v[32:33], v[20:21] op_sel_hi:[1,0]
    ds_write_b32 v2, v46 offset:9248
    v_pk_fma_f32 v[34:35], v[32:33], v[20:21], v[40:41] op_sel:[1,1,0] op_sel_hi:[0,1,1] neg_lo:[1,0,0]
    v_pk_mul_f32 v[38:39], v[36:37], v[26:27] op_sel_hi:[1,0]
    v_cvt_pk_bf16_f32 v47, v34, v35
    v_pk_fma_f32 v[36:37], v[36:37], v[26:27], v[38:39] op_sel:[1,1,0] op_sel_hi:[0,1,1] neg_hi:[1,0,0]
    ds_write_b32 v2, v47 offset:272
    v_cvt_pk_bf16_f32 v46, v36, v37
    v_pk_mul_f32 v[40:41], v[34:35], v[20:21] op_sel_hi:[1,0]
    ds_write_b32 v2, v46 offset:9520
    v_pk_fma_f32 v[34:35], v[34:35], v[20:21], v[40:41] op_sel:[1,1,0] op_sel_hi:[0,1,1] neg_lo:[1,0,0]
    v_pk_mul_f32 v[38:39], v[36:37], v[26:27] op_sel_hi:[1,0]
    v_cvt_pk_bf16_f32 v47, v34, v35
    v_pk_fma_f32 v[36:37], v[36:37], v[26:27], v[38:39] op_sel:[1,1,0] op_sel_hi:[0,1,1] neg_hi:[1,0,0]
    ds_write_b32 v2, v47 offset:544
    v_cvt_pk_bf16_f32 v46, v36, v37
    v_pk_mul_f32 v[40:41], v[34:35], v[20:21] op_sel_hi:[1,0]
    ds_write_b32 v2, v46 offset:9792
    v_pk_fma_f32 v[34:35], v[34:35], v[20:21], v[40:41] op_sel:[1,1,0] op_sel_hi:[0,1,1] neg_lo:[1,0,0]
    v_pk_mul_f32 v[38:39], v[36:37], v[26:27] op_sel_hi:[1,0]
    v_cvt_pk_bf16_f32 v47, v34, v35
    v_pk_fma_f32 v[36:37], v[36:37], v[26:27], v[38:39] op_sel:[1,1,0] op_sel_hi:[0,1,1] neg_hi:[1,0,0]
    ds_write_b32 v2, v47 offset:816
    v_cvt_pk_bf16_f32 v46, v36, v37
    v_pk_mul_f32 v[40:41], v[34:35], v[20:21] op_sel_hi:[1,0]
    ds_write_b32 v2, v46 offset:10064
    v_pk_fma_f32 v[34:35], v[34:35], v[20:21], v[40:41] op_sel:[1,1,0] op_sel_hi:[0,1,1] neg_lo:[1,0,0]
    v_pk_mul_f32 v[38:39], v[36:37], v[26:27] op_sel_hi:[1,0]
    v_cvt_pk_bf16_f32 v47, v34, v35
    v_pk_fma_f32 v[36:37], v[36:37], v[26:27], v[38:39] op_sel:[1,1,0] op_sel_hi:[0,1,1] neg_hi:[1,0,0]
    ds_write_b32 v2, v47 offset:2176
    v_cvt_pk_bf16_f32 v46, v36, v37
    v_pk_mul_f32 v[40:41], v[34:35], v[20:21] op_sel_hi:[1,0]
    ds_write_b32 v2, v46 offset:10336
    v_pk_fma_f32 v[34:35], v[34:35], v[20:21], v[40:41] op_sel:[1,1,0] op_sel_hi:[0,1,1] neg_lo:[1,0,0]
    v_pk_mul_f32 v[38:39], v[36:37], v[26:27] op_sel_hi:[1,0]
    v_cvt_pk_bf16_f32 v47, v34, v35
    v_pk_fma_f32 v[36:37], v[36:37], v[26:27], v[38:39] op_sel:[1,1,0] op_sel_hi:[0,1,1] neg_hi:[1,0,0]
    ds_write_b32 v2, v47 offset:2448
    v_cvt_pk_bf16_f32 v46, v36, v37
    v_pk_mul_f32 v[40:41], v[34:35], v[20:21] op_sel_hi:[1,0]
    ds_write_b32 v2, v46 offset:10608
    v_pk_fma_f32 v[34:35], v[34:35], v[20:21], v[40:41] op_sel:[1,1,0] op_sel_hi:[0,1,1] neg_lo:[1,0,0]
    v_pk_mul_f32 v[38:39], v[36:37], v[26:27] op_sel_hi:[1,0]
    v_cvt_pk_bf16_f32 v47, v34, v35
    v_pk_fma_f32 v[36:37], v[36:37], v[26:27], v[38:39] op_sel:[1,1,0] op_sel_hi:[0,1,1] neg_hi:[1,0,0]
    ds_write_b32 v2, v47 offset:2720
    v_cvt_pk_bf16_f32 v46, v36, v37
    v_pk_mul_f32 v[40:41], v[34:35], v[20:21] op_sel_hi:[1,0]
    ds_write_b32 v2, v46 offset:10880
    v_pk_fma_f32 v[34:35], v[34:35], v[20:21], v[40:41] op_sel:[1,1,0] op_sel_hi:[0,1,1] neg_lo:[1,0,0]
    v_pk_mul_f32 v[38:39], v[36:37], v[26:27] op_sel_hi:[1,0]
    v_cvt_pk_bf16_f32 v47, v34, v35
    v_pk_fma_f32 v[36:37], v[36:37], v[26:27], v[38:39] op_sel:[1,1,0] op_sel_hi:[0,1,1] neg_hi:[1,0,0]
    ds_write_b32 v2, v47 offset:2992
    v_cvt_pk_bf16_f32 v46, v36, v37
    v_pk_mul_f32 v[40:41], v[32:33], v[28:29] op_sel_hi:[1,0]
    ds_write_b32 v2, v46 offset:11152
    v_pk_fma_f32 v[32:33], v[32:33], v[28:29], v[40:41] op_sel:[1,1,0] op_sel_hi:[0,1,1] neg_lo:[1,0,0]
    v_pk_mul_f32 v[38:39], v[36:37], v[26:27] op_sel_hi:[1,0]
    v_cvt_pk_bf16_f32 v47, v32, v33
    v_pk_fma_f32 v[36:37], v[36:37], v[26:27], v[38:39] op_sel:[1,1,0] op_sel_hi:[0,1,1] neg_hi:[1,0,0]
    ds_write_b32 v2, v47 offset:1088
    v_cvt_pk_bf16_f32 v46, v36, v37
    ds_write_b32 v2, v47 offset:1360
    ds_write_b32 v2, v46 offset:11424
    v_pk_mul_f32 v[40:41], v[32:33], v[22:23] op_sel_hi:[1,0]
    v_pk_mul_f32 v[38:39], v[36:37], v[26:27] op_sel_hi:[1,0]
    v_pk_fma_f32 v[34:35], v[32:33], v[22:23], v[40:41] op_sel:[1,1,0] op_sel_hi:[0,1,1] neg_lo:[1,0,0]
    s_cmp_lg_u32 s3, 7
    s_cbranch_scc1 B_nosig
    s_waitcnt vmcnt(2)
    v_mov_b32 v60, 1
    s_mov_b64 exec, 1
    buffer_atomic_add v60, off, s[56:59], 0 sc0 sc1
    s_mov_b64 exec, -1
B_nosig:
    v_pk_fma_f32 v[36:37], v[36:37], v[26:27], v[38:39] op_sel:[1,1,0] op_sel_hi:[0,1,1] neg_hi:[1,0,0]
    v_cvt_pk_bf16_f32 v47, v34, v35
    v_cvt_pk_bf16_f32 v46, v36, v37
    ds_write_b32 v2, v47 offset:1632
    ds_write_b32 v2, v46 offset:11696
    v_pk_mul_f32 v[40:41], v[34:35], v[22:23] op_sel_hi:[1,0]
    v_pk_mul_f32 v[38:39], v[36:37], v[26:27] op_sel_hi:[1,0]
    v_pk_fma_f32 v[34:35], v[34:35], v[22:23], v[40:41] op_sel:[1,1,0] op_sel_hi:[0,1,1] neg_lo:[1,0,0]
    v_pk_fma_f32 v[36:37], v[36:37], v[26:27], v[38:39] op_sel:[1,1,0] op_sel_hi:[0,1,1] neg_hi:[1,0,0]
    v_cvt_pk_bf16_f32 v47, v34, v35
    buffer_load_dwordx2 v[244:245], v13, s[32:35], s63 offen offset:2048
    v_cvt_pk_bf16_f32 v46, v36, v37
    ds_write_b32 v2, v47 offset:1904
    ds_write_b32 v2, v46 offset:11968
    ds_write_b32 v2, v47 offset:3264
    v_pk_mul_f32 v[38:39], v[36:37], v[26:27] op_sel_hi:[1,0]
    ds_write_b32 v2, v47 offset:3536
    v_pk_fma_f32 v[36:37], v[36:37], v[26:27], v[38:39] op_sel:[1,1,0] op_sel_hi:[0,1,1] neg_hi:[1,0,0]
    v_pk_mul_f32 v[40:41], v[34:35], v[22:23] op_sel_hi:[1,0]
    v_cvt_pk_bf16_f32 v46, v36, v37
    v_pk_fma_f32 v[34:35], v[34:35], v[22:23], v[40:41] op_sel:[1,1,0] op_sel_hi:[0,1,1] neg_lo:[1,0,0]
    ds_write_b32 v2, v46 offset:12240
    v_cvt_pk_bf16_f32 v47, v34, v35
    v_pk_mul_f32 v[38:39], v[36:37], v[26:27] op_sel_hi:[1,0]
    ds_write_b32 v2, v47 offset:3808
    v_pk_fma_f32 v[36:37], v[36:37], v[26:27], v[38:39] op_sel:[1,1,0] op_sel_hi:[0,1,1] neg_hi:[1,0,0]
    v_pk_mul_f32 v[40:41], v[34:35], v[22:23] op_sel_hi:[1,0]
    v_cvt_pk_bf16_f32 v46, v36, v37
    v_pk_fma_f32 v[34:35], v[34:35], v[22:23], v[40:41] op_sel:[1,1,0] op_sel_hi:[0,1,1] neg_lo:[1,0,0]
    ds_write_b32 v2, v46 offset:12512
    v_cvt_pk_bf16_f32 v47, v34, v35
    v_pk_mul_f32 v[38:39], v[36:37], v[26:27] op_sel_hi:[1,0]
    ds_write_b32 v2, v47 offset:4080
    v_pk_fma_f32 v[36:37], v[36:37], v[26:27], v[38:39] op_sel:[1,1,0] op_sel_hi:[0,1,1] neg_hi:[1,0,0]
    v_pk_mul_f32 v[40:41], v[32:33], v[28:29] op_sel_hi:[1,0]
    v_cvt_pk_bf16_f32 v46, v36, v37
    v_pk_fma_f32 v[32:33], v[32:33], v[28:29], v[40:41] op_sel:[1,1,0] op_sel_hi:[0,1,1] neg_lo:[1,0,0]
    ds_write_b32 v2, v46 offset:12784
    v_cvt_pk_bf16_f32 v47, v32, v33
    v_pk_mul_f32 v[38:39], v[36:37], v[26:27] op_sel_hi:[1,0]
    ds_write_b32 v2, v47 offset:4352
    v_pk_fma_f32 v[36:37], v[36:37], v[26:27], v[38:39] op_sel:[1,1,0] op_sel_hi:[0,1,1] neg_hi:[1,0,0]
    v_pk_mul_f32 v[40:41], v[32:33], v[24:25] op_sel_hi:[1,0]
    v_cvt_pk_bf16_f32 v46, v36, v37
    v_pk_fma_f32 v[34:35], v[32:33], v[24:25], v[40:41] op_sel:[1,1,0] op_sel_hi:[0,1,1] neg_lo:[1,0,0]
    ds_write_b32 v2, v46 offset:13056
    v_cvt_pk_bf16_f32 v47, v34, v35
    v_pk_mul_f32 v[38:39], v[36:37], v[26:27] op_sel_hi:[1,0]
    ds_write_b32 v2, v47 offset:4624
    v_pk_fma_f32 v[36:37], v[36:37], v[26:27], v[38:39] op_sel:[1,1,0] op_sel_hi:[0,1,1] neg_hi:[1,0,0]
    v_pk_mul_f32 v[40:41], v[34:35], v[24:25] op_sel_hi:[1,0]
    v_cvt_pk_bf16_f32 v46, v36, v37
    v_pk_fma_f32 v[34:35], v[34:35], v[24:25], v[40:41] op_sel:[1,1,0] op_sel_hi:[0,1,1] neg_lo:[1,0,0]
    ds_write_b32 v2, v46 offset:13328
    v_cvt_pk_bf16_f32 v47, v34, v35
    v_pk_mul_f32 v[38:39], v[36:37], v[26:27] op_sel_hi:[1,0]
    ds_write_b32 v2, v47 offset:4896
    v_pk_fma_f32 v[36:37], v[36:37], v[26:27], v[38:39] op_sel:[1,1,0] op_sel_hi:[0,1,1] neg_hi:[1,0,0]
    v_pk_mul_f32 v[40:41], v[32:33], v[28:29] op_sel_hi:[1,0]
    v_cvt_pk_bf16_f32 v46, v36, v37
    v_pk_fma_f32 v[32:33], v[32:33], v[28:29], v[40:41] op_sel:[1,1,0] op_sel_hi:[0,1,1] neg_lo:[1,0,0]
    ds_write_b32 v2, v46 offset:13600
    v_cvt_pk_bf16_f32 v47, v32, v33
    v_pk_mul_f32 v[38:39], v[36:37], v[26:27] op_sel_hi:[1,0]
    ds_write_b32 v2, v47 offset:5440
    v_pk_fma_f32 v[36:37], v[36:37], v[26:27], v[38:39] op_sel:[1,1,0] op_sel_hi:[0,1,1] neg_hi:[1,0,0]
    v_pk_mul_f32 v[40:41], v[32:33], v[24:25] op_sel_hi:[1,0]
    v_cvt_pk_bf16_f32 v46, v36, v37
    v_pk_fma_f32 v[34:35], v[32:33], v[24:25], v[40:41] op_sel:[1,1,0] op_sel_hi:[0,1,1] neg_lo:[1,0,0]
    ds_write_b32 v2, v46 offset:13872
    v_cvt_pk_bf16_f32 v47, v34, v35
    v_pk_mul_f32 v[38:39], v[36:37], v[26:27] op_sel_hi:[1,0]
    ds_write_b32 v2, v47 offset:5712
    v_pk_fma_f32 v[36:37], v[36:37], v[26:27], v[38:39] op_sel:[1,1,0] op_sel_hi:[0,1,1] neg_hi:[1,0,0]
    v_pk_mul_f32 v[40:41], v[34:35], v[24:25] op_sel_hi:[1,0]
    v_cvt_pk_bf16_f32 v46, v36, v37
    v_pk_fma_f32 v[34:35], v[34:35], v[24:25], v[40:41] op_sel:[1,1,0] op_sel_hi:[0,1,1] neg_lo:[1,0,0]
    ds_write_b32 v2, v46 offset:14144
    v_cvt_pk_bf16_f32 v47, v34, v35
    v_pk_mul_f32 v[38:39], v[36:37], v[26:27] op_sel_hi:[1,0]
    ds_write_b32 v2, v47 offset:5984
    v_pk_fma_f32 v[36:37], v[36:37], v[26:27], v[38:39] op_sel:[1,1,0] op_sel_hi:[0,1,1] neg_hi:[1,0,0]
    v_pk_mul_f32 v[40:41], v[32:33], v[28:29] op_sel_hi:[1,0]
    v_cvt_pk_bf16_f32 v46, v36, v37
    v_pk_fma_f32 v[32:33], v[32:33], v[28:29], v[40:41] op_sel:[1,1,0] op_sel_hi:[0,1,1] neg_lo:[1,0,0]
    ds_write_b32 v2, v46 offset:14416
    v_cvt_pk_bf16_f32 v47, v32, v33
    v_pk_mul_f32 v[38:39], v[36:37], v[26:27] op_sel_hi:[1,0]
    ds_write_b32 v2, v47 offset:6528
    v_pk_fma_f32 v[36:37], v[36:37], v[26:27], v[38:39] op_sel:[1,1,0] op_sel_hi:[0,1,1] neg_hi:[1,0,0]
    v_pk_mul_f32 v[40:41], v[32:33], v[26:27] op_sel_hi:[1,0]
    v_cvt_pk_bf16_f32 v46, v36, v37
    v_pk_fma_f32 v[34:35], v[32:33], v[26:27], v[40:41] op_sel:[1,1,0] op_sel_hi:[0,1,1] neg_lo:[1,0,0]
    ds_write_b32 v2, v46 offset:14688
    v_cvt_pk_bf16_f32 v47, v34, v35
    v_pk_mul_f32 v[38:39], v[36:37], v[26:27] op_sel_hi:[1,0]
    ds_write_b32 v2, v47 offset:6800
    v_pk_fma_f32 v[36:37], v[36:37], v[26:27], v[38:39] op_sel:[1,1,0] op_sel_hi:[0,1,1] neg_hi:[1,0,0]
    v_pk_mul_f32 v[40:41], v[32:33], v[28:29] op_sel_hi:[1,0]
    v_cvt_pk_bf16_f32 v46, v36, v37
    v_pk_fma_f32 v[32:33], v[32:33], v[28:29], v[40:41] op_sel:[1,1,0] op_sel_hi:[0,1,1] neg_lo:[1,0,0]
    buffer_load_dwordx2 v[246:247], v13, s[32:35], s63 offen offset:3072
    ds_write_b32 v2, v46 offset:14960
    v_cvt_pk_bf16_f32 v47, v32, v33
    v_pk_mul_f32 v[38:39], v[36:37], v[26:27] op_sel_hi:[1,0]
    ds_write_b32 v2, v47 offset:7616
    v_pk_fma_f32 v[36:37], v[36:37], v[26:27], v[38:39] op_sel:[1,1,0] op_sel_hi:[0,1,1] neg_hi:[1,0,0]
    v_pk_mul_f32 v[40:41], v[32:33], v[26:27] op_sel_hi:[1,0]
    v_cvt_pk_bf16_f32 v46, v36, v37
    v_pk_fma_f32 v[34:35], v[32:33], v[26:27], v[40:41] op_sel:[1,1,0] op_sel_hi:[0,1,1] neg_lo:[1,0,0]
    ds_write_b32 v2, v46 offset:15232
    v_cvt_pk_bf16_f32 v47, v34, v35
    v_pk_mul_f32 v[38:39], v[36:37], v[26:27] op_sel_hi:[1,0]
    ds_write_b32 v2, v47 offset:7888
    v_pk_fma_f32 v[36:37], v[36:37], v[26:27], v[38:39] op_sel:[1,1,0] op_sel_hi:[0,1,1] neg_hi:[1,0,0]
    v_pk_mul_f32 v[40:41], v[32:33], v[28:29] op_sel_hi:[1,0]
    v_cvt_pk_bf16_f32 v46, v36, v37
    v_pk_fma_f32 v[32:33], v[32:33], v[28:29], v[40:41] op_sel:[1,1,0] op_sel_hi:[0,1,1] neg_lo:[1,0,0]
    ds_write_b32 v2, v46 offset:15504
    v_cvt_pk_bf16_f32 v47, v32, v33
    v_pk_mul_f32 v[38:39], v[36:37], v[26:27] op_sel_hi:[1,0]
    ds_write_b32 v2, v47 offset:7072
    v_pk_fma_f32 v[36:37], v[36:37], v[26:27], v[38:39] op_sel:[1,1,0] op_sel_hi:[0,1,1] neg_hi:[1,0,0]
    v_pk_mul_f32 v[40:41], v[32:33], v[26:27] op_sel_hi:[1,0]
    v_cvt_pk_bf16_f32 v46, v36, v37
    v_pk_fma_f32 v[34:35], v[32:33], v[26:27], v[40:41] op_sel:[1,1,0] op_sel_hi:[0,1,1] neg_lo:[1,0,0]
    ds_write_b32 v2, v46 offset:15776
    v_cvt_pk_bf16_f32 v47, v34, v35
    v_pk_mul_f32 v[38:39], v[36:37], v[26:27] op_sel_hi:[1,0]
    ds_write_b32 v2, v47 offset:7344
    v_pk_fma_f32 v[36:37], v[36:37], v[26:27], v[38:39] op_sel:[1,1,0] op_sel_hi:[0,1,1] neg_hi:[1,0,0]
    v_pk_mul_f32 v[40:41], v[32:33], v[28:29] op_sel_hi:[1,0]
    v_cvt_pk_bf16_f32 v46, v36, v37
    v_pk_fma_f32 v[32:33], v[32:33], v[28:29], v[40:41] op_sel:[1,1,0] op_sel_hi:[0,1,1] neg_lo:[1,0,0]
    ds_write_b32 v2, v46 offset:16048
    v_cvt_pk_bf16_f32 v47, v32, v33
    v_pk_mul_f32 v[38:39], v[36:37], v[26:27] op_sel_hi:[1,0]
    ds_write_b32 v2, v47 offset:8160
    v_pk_fma_f32 v[36:37], v[36:37], v[26:27], v[38:39] op_sel:[1,1,0] op_sel_hi:[0,1,1] neg_hi:[1,0,0]
    v_pk_mul_f32 v[40:41], v[32:33], v[26:27] op_sel_hi:[1,0]
    v_cvt_pk_bf16_f32 v46, v36, v37
    v_pk_fma_f32 v[34:35], v[32:33], v[26:27], v[40:41] op_sel:[1,1,0] op_sel_hi:[0,1,1] neg_lo:[1,0,0]
    ds_write_b32 v2, v46 offset:16320
    v_cvt_pk_bf16_f32 v47, v34, v35
    v_pk_mul_f32 v[38:39], v[36:37], v[26:27] op_sel_hi:[1,0]
    ds_write_b32 v2, v47 offset:8432
    v_pk_fma_f32 v[36:37], v[36:37], v[26:27], v[38:39] op_sel:[1,1,0] op_sel_hi:[0,1,1] neg_hi:[1,0,0]
    v_cvt_pk_bf16_f32 v46, v36, v37
    ds_write_b32 v2, v46 offset:16592
    v_pk_mul_f32 v[38:39], v[36:37], v[26:27] op_sel_hi:[1,0]
    v_pk_fma_f32 v[36:37], v[36:37], v[26:27], v[38:39] op_sel:[1,1,0] op_sel_hi:[0,1,1] neg_hi:[1,0,0]
    v_cvt_pk_bf16_f32 v46, v36, v37
    ds_write_b32 v2, v46 offset:16864
    v_pk_mul_f32 v[38:39], v[36:37], v[26:27] op_sel_hi:[1,0]
    v_pk_fma_f32 v[36:37], v[36:37], v[26:27], v[38:39] op_sel:[1,1,0] op_sel_hi:[0,1,1] neg_hi:[1,0,0]
    v_cvt_pk_bf16_f32 v46, v36, v37
    ds_write_b32 v2, v46 offset:17136
    buffer_load_dword v238, v54, s[28:31], s72 offen
    s_waitcnt lgkmcnt(0)
    ds_read_b128 v[64:67], v3 offset:0
    ds_read_b128 v[96:99], v3 offset:8704
    ds_read_b128 v[68:71], v3 offset:32
    ds_read_b128 v[100:103], v3 offset:8736
    ds_read_b128 v[72:75], v3 offset:64
    ds_read_b128 v[104:107], v3 offset:8768
    ds_read_b128 v[76:79], v3 offset:96
    ds_read_b128 v[108:111], v3 offset:8800
    ds_read_b128 v[80:83], v3 offset:128
    ds_read_b128 v[112:115], v3 offset:8832
    ds_read_b128 v[84:87], v3 offset:160
    ds_read_b128 v[116:119], v3 offset:8864
    ds_read_b128 v[88:91], v3 offset:192
    ds_read_b128 v[120:123], v3 offset:8896
    ds_read_b128 v[92:95], v3 offset:224
    ds_read_b128 v[124:127], v3 offset:8928
    s_lshl_b32 s4, s3, 11
    s_add_u32 s4, s4, 147456
    v_lshl_add_u32 v4, v1, 4, s4
    v_xor_b32 v5, 0x800, v4
    s_mul_i32 s68, s70, 8448
    s_add_u32 s68, s68, 102464
    s_add_u32 s4, s68, 1008
    v_lshlrev_b32 v6, 4, v1
    v_sub_u32 v7, s4, v6
    v_mov_b64 v[48:49], 0
    v_mov_b64 v[50:51], 0
    s_waitcnt lgkmcnt(14)
    v_mfma_f32_32x32x16_bf16 v[128:143], v[64:67], v[96:99], 0
    s_waitcnt lgkmcnt(12)
    v_mfma_f32_32x32x16_bf16 v[128:143], v[68:71], v[100:103], v[128:143]
    s_waitcnt lgkmcnt(10)
    v_mfma_f32_32x32x16_bf16 v[128:143], v[72:75], v[104:107], v[128:143]
    s_waitcnt lgkmcnt(8)
    v_mfma_f32_32x32x16_bf16 v[128:143], v[76:79], v[108:111], v[128:143]
    s_waitcnt lgkmcnt(6)
    v_mfma_f32_32x32x16_bf16 v[128:143], v[80:83], v[112:115], v[128:143]
    s_waitcnt lgkmcnt(4)
    v_mfma_f32_32x32x16_bf16 v[128:143], v[84:87], v[116:119], v[128:143]
    s_waitcnt lgkmcnt(2)
    v_mfma_f32_32x32x16_bf16 v[128:143], v[88:91], v[120:123], v[128:143]
    s_waitcnt lgkmcnt(0)
    v_mfma_f32_32x32x16_bf16 v[128:143], v[92:95], v[124:127], v[128:143]
    s_mul_i32 s69, s3, 4608
    s_add_u32 s69, s69, 65536
    v_add_u32 v8, s69, v6
    v_add_u32 v9, s68, v6
    s_nop 7
    s_cmp_lg_u32 s71, 0
    s_cbranch_scc1 B_w1
    ds_write_b128 v4, v[136:139]
    ds_write_b128 v4, v[140:143] offset:1024
    s_waitcnt lgkmcnt(0)
    s_barrier
    ds_read_b128 v[16:19], v5
    ds_read_b128 v[20:23], v5 offset:1024
    s_mov_b32 exec_hi, 0
    ds_write_b128 v8, v[48:51]
    s_mov_b32 exec_hi, -1
    s_waitcnt lgkmcnt(1)
    v_pk_add_f32 v[16:17], v[16:17], v[128:129]
    v_pk_add_f32 v[18:19], v[18:19], v[130:131]
    v_pk_add_f32 v[20:21], v[20:21], v[132:133]
    v_pk_add_f32 v[22:23], v[22:23], v[134:135]
    v_cvt_pk_bf16_f32 v24, v23, v22
    v_cvt_pk_bf16_f32 v25, v21, v20
    v_cvt_pk_bf16_f32 v26, v19, v18
    v_cvt_pk_bf16_f32 v27, v17, v16
    ds_write_b128 v7, v[24:27] offset:7296
    v_cvt_pk_bf16_f32 v28, v22, v21
    v_cvt_pk_bf16_f32 v29, v20, v19
    v_cvt_pk_bf16_f32 v30, v18, v17
    v_cvt_pk_bf16_f32 v31, v16, 0
    ds_write_b128 v7, v[28:31] offset:3072
    s_bitset0_b32 exec_hi, 31
    ds_write_b16 v7, v24 offset:3070
    s_mov_b64 exec, 15
    ds_write_b128 v9, v[48:51] offset:4096
    ds_write_b128 v9, v[48:51] offset:8320
    s_mov_b64 exec, 1
    ds_write_b32 v8, v48 offset:512
    s_mov_b64 exec, -1
    s_branch B_cv
B_w1:
    s_cmp_lg_u32 s3, 7
    s_cbranch_scc1 B_nogo
    s_waitcnt vmcnt(3)
    v_readfirstlane_b32 s4, v60
    s_cmp_lg_u32 s4, 127
    s_cbranch_scc1 B_nogo
    buffer_store_dword v56, off, s[56:59], 0 offset:128 sc1
B_nogo:
    ds_write_b128 v4, v[128:131]
    ds_write_b128 v4, v[132:135] offset:1024
    s_waitcnt lgkmcnt(0)
    s_barrier
    ds_read_b128 v[16:19], v5
    ds_read_b128 v[20:23], v5 offset:1024
    s_mov_b32 exec_hi, 0
    ds_write_b128 v8, v[48:51]
    s_mov_b32 exec_hi, -1
    s_waitcnt lgkmcnt(1)
    v_pk_add_f32 v[16:17], v[16:17], v[136:137]
    v_pk_add_f32 v[18:19], v[18:19], v[138:139]
    v_pk_add_f32 v[20:21], v[20:21], v[140:141]
    v_pk_add_f32 v[22:23], v[22:23], v[142:143]
    s_mov_b32 vcc_lo, 0xaaaaaaaa
    s_mov_b32 vcc_hi, vcc_lo
    v_cvt_pk_bf16_f32 v24, v18, v18
    v_cvt_pk_bf16_f32 v25, v17, v17
    v_cvt_pk_bf16_f32 v26, v17, v16
    v_cvt_pk_bf16_f32 v27, v16, v16
    ds_write_b128 v7, v[24:27] offset:6272
    v_cvt_pk_bf16_f32 v28, v18, v17
    v_cvt_pk_bf16_f32 v29, v17, v17
    v_cvt_pk_bf16_f32 v30, v16, v16
    v_cvt_pk_bf16_f32 v31, v16, v16
    ds_write_b128 v7, v[28:31] offset:2048
    v_cndmask_b32 v19, v20, v21, vcc
    v_cvt_pk_bf16_f32 v32, v21, v21
    v_cvt_pk_bf16_f32 v33, v21, v19
    v_cvt_pk_bf16_f32 v34, v20, v20
    v_cvt_pk_bf16_f32 v35, v20, v20
    ds_write_b128 v7, v[32:35] offset:5248
    v_cvt_pk_bf16_f32 v36, v21, v21
    v_cvt_pk_bf16_f32 v37, v19, v20
    v_cvt_pk_bf16_f32 v38, v20, v20
    v_cvt_pk_bf16_f32 v39, v20, v20
    ds_write_b128 v7, v[36:39] offset:1024
    v_cndmask_b32 v19, v22, v23, vcc
    v_cvt_pk_bf16_f32 v40, v23, v23
    v_cvt_pk_bf16_f32 v41, v23, v19
    v_cvt_pk_bf16_f32 v42, v22, v22
    v_cvt_pk_bf16_f32 v43, v22, v22
    ds_write_b128 v7, v[40:43] offset:4224
    v_cvt_pk_bf16_f32 v44, v23, v23
    v_cvt_pk_bf16_f32 v45, v19, v22
    v_cvt_pk_bf16_f32 v46, v22, v22
    v_cvt_pk_bf16_f32 v47, v22, v22
    ds_write_b128 v7, v[44:47] offset:0
B_cv:
    v_and_b32 v2, 1, v1
    v_bfe_u32 v3, v1, 1, 3
    v_lshrrev_b32 v4, 4, v1
    s_lshl_b32 s4, s71, 8
    s_sub_u32 s5, s68, s4
    s_add_u32 s5, s5, 504
    v_mul_u32_u24 v5, 4224, v2
    v_lshl_add_u32 v5, v4, 4, v5
    v_lshlrev_b32 v6, 3, v3
    v_sub_u32 v5, v5, v6
    v_add_u32 v5, s5, v5
    v_xor_b32 v7, v4, v2
    v_lshlrev_b32 v7, 4, v7
    v_lshl_add_u32 v7, v3, 6, v7
    s_sub_u32 s4, 512, s4
    v_add_u32 v7, s4, v7
    s_mul_i32 s4, s70, 9216
    s_add_u32 s4, s4, 65536
    v_mul_u32_u24 v8, 4608, v2
    v_add_u32 v8, s4, v8
    s_mov_b32 s76, s64
    s_mov_b32 s77, 0
    v_lshrrev_b32 v9, 3, v7
    v_and_b32 v9, 32, v9
    v_xad_u32 v9, v9, v7, v8
    v_mov_b64 v[128:129], 0
    v_mov_b64 v[130:131], 0
    v_mov_b64 v[132:133], 0
    v_mov_b64 v[134:135], 0
    v_mov_b64 v[136:137], 0
    v_mov_b64 v[138:139], 0
    v_mov_b64 v[140:141], 0
    v_mov_b64 v[142:143], 0
    v_mov_b64 v[144:145], 0
    v_mov_b64 v[146:147], 0
    v_mov_b64 v[148:149], 0
    v_mov_b64 v[150:151], 0
    v_mov_b64 v[152:153], 0
    v_mov_b64 v[154:155], 0
    v_mov_b64 v[156:157], 0
    v_mov_b64 v[158:159], 0
    v_lshlrev_b32 v233, 3, v3
    v_lshl_add_u32 v233, v4, 1, v233
    v_bfe_u32 v234, v3, 1, 1
    v_and_b32 v235, 4, v3
    v_xor_b32 v233, v233, v234
    v_xor_b32 v233, v233, v235
    v_lshlrev_b32 v233, 4, v233
    v_lshl_add_u32 v233, v2, 3, v233
    s_lshl_b32 s4, s3, 13
    s_add_u32 s4, s4, 65536
    v_add_u32 v233, s4, v233
    v_xor_b32 v234, 16, v233
    v_bfe_u32 v235, v0, 4, 1
    v_xor_b32 v235, v235, v0
    v_lshlrev_b32 v236, 2, v12
    v_xor_b32 v235, v235, v236
    v_lshlrev_b32 v235, 4, v235
    v_add_u32 v235, 0x10000, v235
    v_lshlrev_b32 v232, 13, v0
    s_add_u32 s72, s63, 1024
    s_add_u32 s73, s63, 5120
    s_and_b32 s24, s22, 0xffff
    s_and_b32 s25, s22, 0xffff0000
    s_and_b32 s26, s23, 0xffff
    s_and_b32 s27, s23, 0xffff0000
    v_lshlrev_b32 v60, 3, v0
    v_add_u32 v61, 0x208, v60
    v_add_u32 v60, 0x200, v60
    v_lshrrev_b32 v62, 3, v60
    v_lshrrev_b32 v63, 3, v61
    v_and_b32 v62, 32, v62
    v_and_b32 v63, 32, v63
    v_xor_b32 v60, v60, v62
    v_xor_b32 v61, v61, v63
    v_add_u32 v60, 0x10000, v60
    v_add_u32 v61, 0x10000, v61
    v_xor_b32 v62, 16, v60
    s_mov_b32 s4, 0x05040100
    s_mov_b32 s5, 0x07060302
    s_waitcnt vmcnt(1)
    v_perm_b32 v16, v242, v240, s4
    v_perm_b32 v17, v246, v244, s4
    ds_write_b64 v62, v[16:17] offset:4608
    ds_write_b32 v60, v16 offset:4
    ds_write_b32 v61, v17 offset:0
    v_perm_b32 v18, v242, v240, s5
    v_perm_b32 v19, v246, v244, s5
    ds_write_b64 v62, v[18:19] offset:13824
    ds_write_b32 v60, v18 offset:9220
    ds_write_b32 v61, v19 offset:9216
    v_perm_b32 v20, v243, v241, s4
    v_perm_b32 v21, v247, v245, s4
    ds_write_b64 v62, v[20:21] offset:23040
    ds_write_b32 v60, v20 offset:18436
    ds_write_b32 v61, v21 offset:18432
    v_perm_b32 v22, v243, v241, s5
    v_perm_b32 v23, v247, v245, s5
    ds_write_b64 v62, v[22:23] offset:32256
    ds_write_b32 v60, v22 offset:27652
    ds_write_b32 v61, v23 offset:27648
    s_waitcnt lgkmcnt(0)
    s_barrier
    ds_read_b64 v[64:65], v5 offset:3584
    ds_read_b64 v[66:67], v5 offset:3592
    ds_read_b128 v[160:163], v9 offset:0
    ds_read_b64 v[68:69], v5 offset:3072
    ds_read_b64 v[70:71], v5 offset:3080
    ds_read_b128 v[164:167], v9 offset:512
    ds_read_b64 v[72:73], v5 offset:2560
    ds_read_b64 v[74:75], v5 offset:2568
    ds_read_b128 v[168:171], v9 offset:1024
    ds_read_b64 v[76:77], v5 offset:2048
    ds_read_b64 v[78:79], v5 offset:2056
    ds_read_b128 v[172:175], v9 offset:1536
    ds_read_b64 v[80:81], v5 offset:1536
    ds_read_b64 v[82:83], v5 offset:1544
    ds_read_b128 v[176:179], v9 offset:2048
    ds_read_b64 v[84:85], v5 offset:1024
    ds_read_b64 v[86:87], v5 offset:1032
    ds_read_b128 v[180:183], v9 offset:2560
    ds_read_b64 v[88:89], v5 offset:512
    ds_read_b64 v[90:91], v5 offset:520
    ds_read_b128 v[184:187], v9 offset:3072
    ds_read_b64 v[92:93], v5 offset:0
    ds_read_b64 v[94:95], v5 offset:8
    ds_read_b128 v[188:191], v9 offset:3584
B_loop:
    v_subrev_u32 v5, 64, v5
    v_subrev_u32 v7, 64, v7
    v_lshrrev_b32 v9, 3, v7
    v_and_b32 v9, 32, v9
    v_xad_u32 v9, v9, v7, v8
    s_add_u32 m0, s76, 0
    s_waitcnt lgkmcnt(12)
    v_mfma_f32_16x16x32_bf16 v[128:131], v[64:67], v[160:163], v[128:131]
    v_mfma_f32_16x16x32_bf16 v[132:135], v[64:67], v[164:167], v[132:135]
    v_mfma_f32_16x16x32_bf16 v[132:135], v[68:71], v[160:163], v[132:135]
    buffer_load_dwordx4 v14, s[44:47], s77 offen lds
    s_add_u32 s77, s77, 0xfc00
    v_mfma_f32_16x16x32_bf16 v[136:139], v[68:71], v[164:167], v[136:139]
    v_mfma_f32_16x16x32_bf16 v[136:139], v[64:67], v[168:171], v[136:139]
    v_mfma_f32_16x16x32_bf16 v[140:143], v[68:71], v[168:171], v[140:143]
    v_mfma_f32_16x16x32_bf16 v[136:139], v[72:75], v[160:163], v[136:139]
    buffer_load_dwordx4 v14, s[44:47], s77 offen offset:1024 lds
    s_add_u32 s77, s77, 0x10400
    v_mfma_f32_16x16x32_bf16 v[140:143], v[72:75], v[164:167], v[140:143]
    v_mfma_f32_16x16x32_bf16 v[144:147], v[72:75], v[168:171], v[144:147]
    v_mfma_f32_16x16x32_bf16 v[140:143], v[64:67], v[172:175], v[140:143]
    ds_read_b64 v[96:97], v5 offset:3584
    v_mfma_f32_16x16x32_bf16 v[144:147], v[68:71], v[172:175], v[144:147]
    ds_read_b64 v[98:99], v5 offset:3592
    v_mfma_f32_16x16x32_bf16 v[148:151], v[72:75], v[172:175], v[148:151]
    ds_read_b128 v[192:195], v9 offset:0
    v_mfma_f32_16x16x32_bf16 v[140:143], v[76:79], v[160:163], v[140:143]
    ds_read_b64 v[100:101], v5 offset:3072
    v_mfma_f32_16x16x32_bf16 v[144:147], v[76:79], v[164:167], v[144:147]
    ds_read_b64 v[102:103], v5 offset:3080
    v_mfma_f32_16x16x32_bf16 v[148:151], v[76:79], v[168:171], v[148:151]
    ds_read_b128 v[196:199], v9 offset:512
    v_mfma_f32_16x16x32_bf16 v[152:155], v[76:79], v[172:175], v[152:155]
    ds_read_b64 v[104:105], v5 offset:2560
    s_waitcnt lgkmcnt(15)
    v_mfma_f32_16x16x32_bf16 v[144:147], v[64:67], v[176:179], v[144:147]
    ds_read_b64 v[106:107], v5 offset:2568
    v_mfma_f32_16x16x32_bf16 v[148:151], v[68:71], v[176:179], v[148:151]
    ds_read_b128 v[200:203], v9 offset:1024
    v_mfma_f32_16x16x32_bf16 v[152:155], v[72:75], v[176:179], v[152:155]
    ds_read_b64 v[108:109], v5 offset:2048
    v_mfma_f32_16x16x32_bf16 v[156:159], v[76:79], v[176:179], v[156:159]
    ds_read_b64 v[110:111], v5 offset:2056
    v_mfma_f32_16x16x32_bf16 v[144:147], v[80:83], v[160:163], v[144:147]
    ds_read_b128 v[204:207], v9 offset:1536
    v_mfma_f32_16x16x32_bf16 v[148:151], v[80:83], v[164:167], v[148:151]
    ds_read_b64 v[112:113], v5 offset:1536
    v_mfma_f32_16x16x32_bf16 v[152:155], v[80:83], v[168:171], v[152:155]
    ds_read_b64 v[114:115], v5 offset:1544
    v_mfma_f32_16x16x32_bf16 v[156:159], v[80:83], v[172:175], v[156:159]
    ds_read_b128 v[208:211], v9 offset:2048
    s_waitcnt lgkmcnt(15)
    v_mfma_f32_16x16x32_bf16 v[148:151], v[64:67], v[180:183], v[148:151]
    ds_read_b64 v[116:117], v5 offset:1024
    v_mfma_f32_16x16x32_bf16 v[152:155], v[68:71], v[180:183], v[152:155]
    ds_read_b64 v[118:119], v5 offset:1032
    v_mfma_f32_16x16x32_bf16 v[156:159], v[72:75], v[180:183], v[156:159]
    ds_read_b128 v[212:215], v9 offset:2560
    v_mfma_f32_16x16x32_bf16 v[148:151], v[84:87], v[160:163], v[148:151]
    ds_read_b64 v[120:121], v5 offset:512
    v_mfma_f32_16x16x32_bf16 v[152:155], v[84:87], v[164:167], v[152:155]
    ds_read_b64 v[122:123], v5 offset:520
    v_mfma_f32_16x16x32_bf16 v[156:159], v[84:87], v[168:171], v[156:159]
    ds_read_b128 v[216:219], v9 offset:3072
    s_waitcnt lgkmcnt(15)
    v_mfma_f32_16x16x32_bf16 v[152:155], v[64:67], v[184:187], v[152:155]
    ds_read_b64 v[124:125], v5 offset:0
    v_mfma_f32_16x16x32_bf16 v[156:159], v[68:71], v[184:187], v[156:159]
    ds_read_b64 v[126:127], v5 offset:8
    v_mfma_f32_16x16x32_bf16 v[152:155], v[88:91], v[160:163], v[152:155]
    ds_read_b128 v[220:223], v9 offset:3584
    v_mfma_f32_16x16x32_bf16 v[156:159], v[88:91], v[164:167], v[156:159]
    s_waitcnt lgkmcnt(15)
    v_mfma_f32_16x16x32_bf16 v[156:159], v[64:67], v[188:191], v[156:159]
    v_mfma_f32_16x16x32_bf16 v[156:159], v[92:95], v[160:163], v[156:159]
    v_subrev_u32 v5, 64, v5
    v_subrev_u32 v7, 64, v7
    v_lshrrev_b32 v9, 3, v7
    v_and_b32 v9, 32, v9
    v_xad_u32 v9, v9, v7, v8
    s_add_u32 m0, s76, 2048
    s_waitcnt lgkmcnt(12)
    v_mfma_f32_16x16x32_bf16 v[128:131], v[96:99], v[192:195], v[128:131]
    v_mfma_f32_16x16x32_bf16 v[132:135], v[96:99], v[196:199], v[132:135]
    v_mfma_f32_16x16x32_bf16 v[132:135], v[100:103], v[192:195], v[132:135]
    buffer_load_dwordx4 v14, s[44:47], s77 offen lds
    s_add_u32 s77, s77, 0xfc00
    v_mfma_f32_16x16x32_bf16 v[136:139], v[100:103], v[196:199], v[136:139]
    v_mfma_f32_16x16x32_bf16 v[136:139], v[96:99], v[200:203], v[136:139]
    s_cmp_lg_u32 s3, 7
    s_cbranch_scc1 B_cl
    buffer_load_dword v13, off, s[56:59], 0 offset:128 sc1
B_cl:
    v_mfma_f32_16x16x32_bf16 v[140:143], v[100:103], v[200:203], v[140:143]
    v_mfma_f32_16x16x32_bf16 v[136:139], v[104:107], v[192:195], v[136:139]
    buffer_load_dwordx4 v14, s[44:47], s77 offen offset:1024 lds
    s_add_u32 s77, s77, 0x10400
    v_mfma_f32_16x16x32_bf16 v[140:143], v[104:107], v[196:199], v[140:143]
    v_mfma_f32_16x16x32_bf16 v[144:147], v[104:107], v[200:203], v[144:147]
    v_mfma_f32_16x16x32_bf16 v[140:143], v[96:99], v[204:207], v[140:143]
    ds_read_b64 v[64:65], v5 offset:3584
    v_mfma_f32_16x16x32_bf16 v[144:147], v[100:103], v[204:207], v[144:147]
    ds_read_b64 v[66:67], v5 offset:3592
    v_mfma_f32_16x16x32_bf16 v[148:151], v[104:107], v[204:207], v[148:151]
    ds_read_b128 v[160:163], v9 offset:0
    v_mfma_f32_16x16x32_bf16 v[140:143], v[108:111], v[192:195], v[140:143]
    ds_read_b64 v[68:69], v5 offset:3072
    v_mfma_f32_16x16x32_bf16 v[144:147], v[108:111], v[196:199], v[144:147]
    ds_read_b64 v[70:71], v5 offset:3080
    v_mfma_f32_16x16x32_bf16 v[148:151], v[108:111], v[200:203], v[148:151]
    ds_read_b128 v[164:167], v9 offset:512
    v_mfma_f32_16x16x32_bf16 v[152:155], v[108:111], v[204:207], v[152:155]
    ds_read_b64 v[72:73], v5 offset:2560
    s_waitcnt lgkmcnt(15)
    v_mfma_f32_16x16x32_bf16 v[144:147], v[96:99], v[208:211], v[144:147]
    ds_read_b64 v[74:75], v5 offset:2568
    v_mfma_f32_16x16x32_bf16 v[148:151], v[100:103], v[208:211], v[148:151]
    ds_read_b128 v[168:171], v9 offset:1024
    v_mfma_f32_16x16x32_bf16 v[152:155], v[104:107], v[208:211], v[152:155]
    ds_read_b64 v[76:77], v5 offset:2048
    v_mfma_f32_16x16x32_bf16 v[156:159], v[108:111], v[208:211], v[156:159]
    ds_read_b64 v[78:79], v5 offset:2056
    v_mfma_f32_16x16x32_bf16 v[144:147], v[112:115], v[192:195], v[144:147]
    ds_read_b128 v[172:175], v9 offset:1536
    v_mfma_f32_16x16x32_bf16 v[148:151], v[112:115], v[196:199], v[148:151]
    ds_read_b64 v[80:81], v5 offset:1536
    v_mfma_f32_16x16x32_bf16 v[152:155], v[112:115], v[200:203], v[152:155]
    ds_read_b64 v[82:83], v5 offset:1544
    v_mfma_f32_16x16x32_bf16 v[156:159], v[112:115], v[204:207], v[156:159]
    ds_read_b128 v[176:179], v9 offset:2048
    s_waitcnt lgkmcnt(15)
    v_mfma_f32_16x16x32_bf16 v[148:151], v[96:99], v[212:215], v[148:151]
    ds_read_b64 v[84:85], v5 offset:1024
    v_mfma_f32_16x16x32_bf16 v[152:155], v[100:103], v[212:215], v[152:155]
    ds_read_b64 v[86:87], v5 offset:1032
    v_mfma_f32_16x16x32_bf16 v[156:159], v[104:107], v[212:215], v[156:159]
    ds_read_b128 v[180:183], v9 offset:2560
    v_mfma_f32_16x16x32_bf16 v[148:151], v[116:119], v[192:195], v[148:151]
    ds_read_b64 v[88:89], v5 offset:512
    v_mfma_f32_16x16x32_bf16 v[152:155], v[116:119], v[196:199], v[152:155]
    ds_read_b64 v[90:91], v5 offset:520
    v_mfma_f32_16x16x32_bf16 v[156:159], v[116:119], v[200:203], v[156:159]
    ds_read_b128 v[184:187], v9 offset:3072
    s_waitcnt lgkmcnt(15)
    v_mfma_f32_16x16x32_bf16 v[152:155], v[96:99], v[216:219], v[152:155]
    ds_read_b64 v[92:93], v5 offset:0
    v_mfma_f32_16x16x32_bf16 v[156:159], v[100:103], v[216:219], v[156:159]
    ds_read_b64 v[94:95], v5 offset:8
    v_mfma_f32_16x16x32_bf16 v[152:155], v[120:123], v[192:195], v[152:155]
    ds_read_b128 v[188:191], v9 offset:3584
    v_mfma_f32_16x16x32_bf16 v[156:159], v[120:123], v[196:199], v[156:159]
    s_waitcnt lgkmcnt(15)
    v_mfma_f32_16x16x32_bf16 v[156:159], v[96:99], v[220:223], v[156:159]
    v_mfma_f32_16x16x32_bf16 v[156:159], v[124:127], v[192:195], v[156:159]
    s_add_u32 s76, s76, 0x8000
    s_cmp_lt_u32 s76, 0x10000
    s_cbranch_scc1 B_loop
    s_waitcnt lgkmcnt(0)
    s_barrier
    ds_write_b64 v233, v[128:129] offset:0
    ds_write_b64 v234, v[130:131] offset:0
    ds_write_b64 v233, v[132:133] offset:1024
    ds_write_b64 v234, v[134:135] offset:1024
    ds_write_b64 v233, v[136:137] offset:2048
    ds_write_b64 v234, v[138:139] offset:2048
    ds_write_b64 v233, v[140:141] offset:3072
    ds_write_b64 v234, v[142:143] offset:3072
    ds_write_b64 v233, v[144:145] offset:4096
    ds_write_b64 v234, v[146:147] offset:4096
    ds_write_b64 v233, v[148:149] offset:5120
    ds_write_b64 v234, v[150:151] offset:5120
    ds_write_b64 v233, v[152:153] offset:6144
    ds_write_b64 v234, v[154:155] offset:6144
    ds_write_b64 v233, v[156:157] offset:7168
    ds_write_b64 v234, v[158:159] offset:7168
    s_cmp_lg_u32 s3, 7
    s_cbranch_scc1 B_cc_done
    s_mov_b32 s5, 0
B_cc_loop:
    s_waitcnt vmcnt(0)
    v_readfirstlane_b32 s4, v13
    s_add_u32 s5, s5, 1
    s_cmp_lg_u32 s4, 0
    s_cbranch_scc1 B_cc_done
    buffer_load_dword v13, off, s[56:59], 0 offset:128 sc1
    s_cmp_lt_u32 s5, 0x40000
    s_cbranch_scc1 B_cc_loop
B_cc_done:
    s_and_b32 s4, s3, 6
    s_lshr_b32 s5, s66, 1
    s_lshl4_add_u32 s4, s4, s5
    s_mul_i32 s69, s4, 4352
    v_mul_u32_u24 v184, 69632, v12
    s_waitcnt vmcnt(0) lgkmcnt(0)
    s_barrier
    buffer_load_dword v185, v184, s[52:55], s69 offen sc1
    ds_read_b128 v[16:19], v235 offset:0
    ds_read_b128 v[20:23], v235 offset:8192
    ds_read_b128 v[24:27], v235 offset:16384
    ds_read_b128 v[28:31], v235 offset:24576
    ds_read_b128 v[32:35], v235 offset:32768
    ds_read_b128 v[36:39], v235 offset:40960
    ds_read_b128 v[40:43], v235 offset:49152
    ds_read_b128 v[44:47], v235 offset:57344
    s_waitcnt lgkmcnt(6)
    v_pk_add_f32 v[16:17], v[16:17], v[20:21]
    v_pk_add_f32 v[18:19], v[18:19], v[22:23]
    v_dot2_f32_bf16 v16, v240, s24, v16
    v_dot2_f32_bf16 v17, v242, s24, v17
    v_dot2_f32_bf16 v18, v244, s24, v18
    v_dot2_f32_bf16 v19, v246, s24, v19
    s_waitcnt lgkmcnt(4)
    v_pk_add_f32 v[24:25], v[24:25], v[28:29]
    v_pk_add_f32 v[26:27], v[26:27], v[30:31]
    v_dot2_f32_bf16 v24, v240, s25, v24
    v_dot2_f32_bf16 v25, v242, s25, v25
    v_dot2_f32_bf16 v26, v244, s25, v26
    v_dot2_f32_bf16 v27, v246, s25, v27
    s_waitcnt lgkmcnt(2)
    v_pk_add_f32 v[32:33], v[32:33], v[36:37]
    v_pk_add_f32 v[34:35], v[34:35], v[38:39]
    v_dot2_f32_bf16 v32, v241, s26, v32
    v_dot2_f32_bf16 v33, v243, s26, v33
    v_dot2_f32_bf16 v34, v245, s26, v34
    v_dot2_f32_bf16 v35, v247, s26, v35
    s_waitcnt lgkmcnt(0)
    v_pk_add_f32 v[40:41], v[40:41], v[44:45]
    v_pk_add_f32 v[42:43], v[42:43], v[46:47]
    v_dot2_f32_bf16 v40, v241, s27, v40
    v_dot2_f32_bf16 v41, v243, s27, v41
    v_dot2_f32_bf16 v42, v245, s27, v42
    v_dot2_f32_bf16 v43, v247, s27, v43
    v_cvt_pk_bf16_f32 v224, v16, v24
    v_cvt_pk_bf16_f32 v225, v32, v40
    buffer_store_dwordx2 v[224:225], v232, s[48:51], s72 offen offset:0
    v_cvt_pk_bf16_f32 v226, v17, v25
    v_cvt_pk_bf16_f32 v227, v33, v41
    buffer_store_dwordx2 v[226:227], v232, s[48:51], s72 offen offset:2048
    v_cvt_pk_bf16_f32 v228, v18, v26
    v_cvt_pk_bf16_f32 v229, v34, v42
    buffer_store_dwordx2 v[228:229], v232, s[48:51], s73 offen offset:0
    v_cvt_pk_bf16_f32 v230, v19, v27
    v_cvt_pk_bf16_f32 v231, v35, v43
    v_bfe_u32 v6, v1, 1, 3
    v_cmp_eq_u32 s[24:25], 0, v6
    v_cmp_eq_u32 s[26:27], 1, v6
    v_cmp_eq_u32 s[28:29], 2, v6
    v_cmp_eq_u32 s[30:31], 3, v6
    v_cndmask_b32 v104, 0, v11, s[24:25]
    v_cndmask_b32 v105, 0, v11, s[26:27]
    v_cndmask_b32 v106, 0, v11, s[28:29]
    v_cndmask_b32 v107, 0, v11, s[30:31]
    v_cmp_eq_u32 s[24:25], 4, v6
    v_cmp_eq_u32 s[26:27], 5, v6
    v_cmp_eq_u32 s[28:29], 6, v6
    v_cmp_eq_u32 s[30:31], 7, v6
    v_cndmask_b32 v108, 0, v11, s[24:25]
    v_cndmask_b32 v109, 0, v11, s[26:27]
    v_cndmask_b32 v110, 0, v11, s[28:29]
    v_cndmask_b32 v111, 0, v11, s[30:31]
    s_waitcnt vmcnt(3)
    s_mov_b32 s65, 0
B_pc:
    v_cmp_eq_u32 vcc, -1, v185
    s_add_u32 s65, s65, 1
    s_cmp_lt_u32 s65, 0x4000
    s_cselect_b64 s[4:5], -1, 0
    s_and_b64 vcc, vcc, s[4:5]
    s_cbranch_scc0 B_pd
    buffer_load_dword v185, v184, s[52:55], s69 offen sc1
    s_waitcnt vmcnt(0)
    s_branch B_pc
B_pd:
    s_mov_b32 s65, 0
    s_branch OUTP
    s_endpgm
CODEEND:
.section .rodata,"a"
.p2align 6
.amdhsa_kernel concat_heads__linear_kernel_hedgehog__ssm_conv_s4d__prompt_kernel
  .amdhsa_next_free_vgpr 256
  .amdhsa_next_free_sgpr 102
  .amdhsa_accum_offset 256
  .amdhsa_group_segment_fixed_size 0
  .amdhsa_kernarg_size 112
  .amdhsa_user_sgpr_count 2
  .amdhsa_user_sgpr_kernarg_segment_ptr 1
  .amdhsa_system_sgpr_workgroup_id_x 1
.end_amdhsa_kernel
```
